```python
import torch

def _softmax(x, axis=-1):
    return torch.softmax(x, dim=axis)
def _gelu(x):
    return torch.nn.functional.gelu(x, approximate="tanh")
def _silu(x):
    return torch.nn.functional.silu(x)
def _sigmoid(x):
    return torch.sigmoid(x)
def _layernorm(x, axis=-1, eps=1e-5):
    m = x.mean(dim=axis, keepdim=True)
    v = x.var(dim=axis, keepdim=True, unbiased=False)
    return (x - m) / torch.sqrt(v + eps)
def _scatter_add(tgt, idx, src, axis=0):
    return tgt.clone().index_add_(axis, idx, src)
def _segment_sum(src, seg, n):
    out = torch.zeros((n,) + src.shape[1:], dtype=src.dtype)
    return out.index_add_(0, seg, src)
def _pad(x, pw):
    flat = tuple(v for pair in reversed(pw) for v in pair)
    return torch.nn.functional.pad(x, flat)

kernel_name = 'recurrent_scan__gqa_block_cached__dense_activation_squared_relu__decode'

def setup_inputs():

    _w = (lambda a: (lambda t: t.to(torch.bfloat16) if t.is_floating_point() else t)(torch.as_tensor(a)))
    def _A_setup():
        B, Sq, D = 2, 1, 640
        Hq, Hkv, Sk, Dh = 32, 32, 8192, 192
        assert Hq % Hkv == 0, (Hq, Hkv)
        return {
            "x": _w((lambda *s: torch.randn(*s, dtype=torch.bfloat16) * 0.05)(B, Sq, D)),
            "k_cache": _w((lambda *s: torch.randn(*s, dtype=torch.bfloat16) * 1.6)(B, Hkv, Sk, Dh)),
            "v_cache": _w((lambda *s: torch.randn(*s, dtype=torch.bfloat16) * 0.2)(B, Hkv, Sk, Dh)),
            "wq": _w((lambda *s: torch.randn(*s, dtype=torch.bfloat16) * 1.6)(D, Hq * Dh) * (D ** -0.5)),
            "wo": _w((lambda *s: torch.randn(*s, dtype=torch.bfloat16) * 0.2)(Hq * Dh, D) * ((Hq * Dh) ** -0.5)),
        }
    _A_in = _A_setup()

    def _B_setup():
        B, S, D, F = 2, 1, 640, 1536
        return {
            "x": _w((lambda *s: torch.randn(*s, dtype=torch.bfloat16) * 0.05)(B, S, D)),
            "w1": _w((lambda *s: torch.randn(*s, dtype=torch.bfloat16) * 0.1)(D, F)),
            "b1": _w((lambda *s: torch.randn(*s, dtype=torch.bfloat16) * 0.1)(F)),
            "w2": _w((lambda *s: torch.randn(*s, dtype=torch.bfloat16) * 0.1)(F, D)),
            "b2": _w((lambda *s: torch.randn(*s, dtype=torch.bfloat16) * 0.1)(D)),
        }
    _B_in = _B_setup()

    return {
        "A_x": _A_in["x"],
        "A_k_cache": _A_in["k_cache"],
        "A_v_cache": _A_in["v_cache"],
        "A_wq": _A_in["wq"],
        "A_wo": _A_in["wo"],
        "B_x": _B_in["x"],
        "B_w1": _B_in["w1"],
        "B_b1": _B_in["b1"],
        "B_w2": _B_in["w2"],
        "B_b2": _B_in["b2"],
    }

def reference(A_x, A_k_cache, A_v_cache, A_wq, A_wo, B_x, B_w1, B_b1, B_w2, B_b2):
    def _A_ref(x, k_cache, v_cache, wq, wo):
        B, Sq, D = x.shape
        Hq, Dh = 32, 192
        Hkv = k_cache.shape[1]
        rep = Hq // Hkv
        q = (lambda x, *d: x.permute(*d))((x @ wq).reshape(B, Sq, Hq, Dh), 0, 2, 1, 3)
        k = (lambda x, n, axis: torch.repeat_interleave(x, n, dim=axis))(k_cache, rep, axis=1)
        v = (lambda x, n, axis: torch.repeat_interleave(x, n, dim=axis))(v_cache, rep, axis=1)
        scores = torch.einsum("bhqd,bhkd->bhqk", q, k) * (Dh ** -0.5)
        p = _softmax(scores, axis=-1)
        o = torch.einsum("bhqk,bhkd->bhqd", p, v)
        return (lambda x, *d: x.permute(*d))(o, 0, 2, 1, 3).reshape(B, Sq, Hq * Dh) @ wo

    def _B_ref(x, w1, b1, w2, b2):
        h = torch.einsum("bsd,df->bsf", x, w1) + b1
        zero = torch.zeros_like(h)
        r = torch.where(h > zero, h, zero)
        h = r * r
        out = torch.einsum("bsf,fd->bsd", h, w2) + b2
        return out

    x = A_x
    xn = _layernorm(x, axis=-1)
    s = _A_ref(xn, A_k_cache, A_v_cache, A_wq, A_wo)
    g = _silu(_B_ref(xn, B_w1, B_b1, B_w2, B_b2))
    return x + s * g
```

```asm
; @launch grid=(256,1,1) block=(512,1,1) lds=28672
.amdgcn_target "amdgcn-amd-amdhsa--gfx950"
.text
.globl recurrent_scan__gqa_block_cached__dense_activation_squared_relu__decode_kernel
.p2align 8
.type recurrent_scan__gqa_block_cached__dense_activation_squared_relu__decode_kernel,@function
recurrent_scan__gqa_block_cached__dense_activation_squared_relu__decode_kernel:
    s_load_dwordx16 s[64:79], s[0:1], 0
    v_lshrrev_b32 v1, 6, v0
    s_lshr_b32 s4, s2, 3
    v_readfirstlane_b32 s3, v1
    s_load_dwordx8 s[80:87], s[0:1], 64
    s_load_dwordx2 s[88:89], s[0:1], 96
    s_cmp_gt_u32 s4, 31
    s_nop 0
    s_cbranch_scc1 L_end
    s_cmp_ge_u32 s3, 4
    s_cbranch_scc1 L_helper
    v_and_b32 v1, 63, v0
    s_and_b32 s5, s2, 7
    v_lshrrev_b32 v2, 3, v1
    v_mul_u32_u24 v2, 384, v2
    v_and_b32 v3, 7, v1
    v_lshl_add_u32 v2, v3, 4, v2
    s_lshl_b32 s44, s4, 8
    s_and_b32 s28, s4, 1
    s_lshl_b32 s31, s28, 13
    s_add_u32 s44, s44, s31
    s_lshl2_add_u32 s44, s5, s44
    s_add_u32 s44, s44, s3
    s_mul_i32 s30, s44, 12288
    s_mov_b32 s10, 201326592
    s_mov_b32 s11, 0x20000
    s_lshr_b32 s38, s4, 3
    s_add_u32 s38, s38, s4
    s_add_u32 s38, s38, s5
    s_and_b32 s38, s38, 7
    s_mov_b32 s39, 0xf5f5f5f5
    s_bitcmp1_b32 s39, s4
    s_cselect_b32 s39, 4, 3
    s_cmp_ge_u32 s38, s39
    s_waitcnt lgkmcnt(0)
    s_mov_b32 s8, s66
    s_mov_b32 s9, s67
    s_cbranch_scc1 L_nb1
    s_barrier
L_nb1:
    buffer_load_dwordx4 v[64:67], v2, s[8:11], s30 offen offset:0 nt
    buffer_load_dwordx4 v[68:71], v2, s[8:11], s30 offen offset:128 nt
    buffer_load_dwordx4 v[72:75], v2, s[8:11], s30 offen offset:256 nt
    buffer_load_dwordx4 v[76:79], v2, s[8:11], s30 offen offset:3072 nt
    buffer_load_dwordx4 v[80:83], v2, s[8:11], s30 offen offset:3200 nt
    buffer_load_dwordx4 v[84:87], v2, s[8:11], s30 offen offset:3328 nt
    v_add_u32 v3, 6144, v2
    s_mov_b32 s12, s68
    s_mov_b32 s13, s69
    s_mov_b32 s14, 201326592
    s_mov_b32 s15, 0x20000
    s_mov_b32 s29, s5
    s_mov_b32 s44, s30
    s_mov_b32 s42, 0
    s_mov_b32 s45, 3
    s_add_u32 s31, s44, 393216
    s_add_u32 s32, s44, 786432
    s_add_u32 s33, s44, 1179648
    s_mov_b32 s48, 3145728
    s_load_dword s47, s[88:89], s48
    v_and_b32 v56, 1, v1
    v_lshlrev_b32 v56, 4, v56
    v_mov_b32 v57, 0xffff
    v_lshlrev_b32 v56, v56, v57
    v_bfe_u32 v57, v1, 1, 2
    v_cmp_eq_u32 vcc, 0, v57
    s_nop 1
    v_cndmask_b32 v16, 0, v56, vcc
    v_cmp_eq_u32 vcc, 1, v57
    s_nop 1
    v_cndmask_b32 v17, 0, v56, vcc
    v_cmp_eq_u32 vcc, 2, v57
    s_nop 1
    v_cndmask_b32 v18, 0, v56, vcc
    v_cmp_eq_u32 vcc, 3, v57
    s_nop 1
    v_cndmask_b32 v19, 0, v56, vcc
    s_mov_b32 s34, 0x3d93cd3a
    s_mov_b32 s35, 0x3fb8aa3b
    v_mov_b32 v20, 0
    v_mov_b32 v21, 0
    v_mov_b32 v22, 0
    v_mov_b32 v23, 0
    v_mov_b32 v24, 0
    v_mov_b32 v25, 0
    v_mov_b32 v26, 0
    v_mov_b32 v27, 0
    v_mov_b32 v28, 0
    v_mov_b32 v29, 0
    v_mov_b32 v30, 0
    v_mov_b32 v31, 0
    v_mov_b32 v32, 0xff800000
    v_mov_b32 v33, 0xff800000
    v_mov_b32 v34, 0
    s_mul_i32 s36, s4, 3145728
    s_add_u32 s36, s36, 100663296
    s_mul_i32 s37, s28, 100663296
    s_sub_u32 s36, s36, s37
    s_mul_i32 s37, s3, 3072
    s_add_u32 s37, s37, s36
    s_add_u32 s37, s37, 1572864
    s_mul_i32 s38, s29, 49152
    s_add_u32 s36, s36, s38
    s_mul_i32 s38, s3, 12288
    s_add_u32 s36, s36, s38
    s_mov_b32 s46, 8
    s_mul_i32 s38, s42, 16385
    s_lshr_b32 s38, s38, 16
    s_mul_i32 s38, s38, 4
    s_sub_u32 s42, s42, s38
    s_waitcnt vmcnt(5)
    buffer_load_dwordx4 v[88:91], v3, s[8:11], s30 offen offset:0 nt
    s_waitcnt vmcnt(5)
    buffer_load_dwordx4 v[92:95], v3, s[8:11], s30 offen offset:128 nt
    s_waitcnt vmcnt(5)
    buffer_load_dwordx4 v[96:99], v3, s[8:11], s30 offen offset:256 nt
    s_waitcnt vmcnt(5)
    buffer_load_dwordx4 v[100:103], v3, s[8:11], s30 offen offset:3072 nt
    s_waitcnt vmcnt(5)
    buffer_load_dwordx4 v[104:107], v3, s[8:11], s30 offen offset:3200 nt
    s_waitcnt vmcnt(5)
    buffer_load_dwordx4 v[108:111], v3, s[8:11], s30 offen offset:3328 nt
    s_waitcnt vmcnt(5)
    buffer_load_dwordx4 v[112:115], v2, s[12:15], s30 offen offset:0 nt
    s_waitcnt vmcnt(5)
    buffer_load_dwordx4 v[116:119], v2, s[12:15], s30 offen offset:128 nt
    s_waitcnt vmcnt(5)
    buffer_load_dwordx4 v[120:123], v2, s[12:15], s30 offen offset:256 nt
    s_waitcnt vmcnt(5)
    buffer_load_dwordx4 v[124:127], v2, s[12:15], s30 offen offset:3072 nt
    s_waitcnt vmcnt(5)
    buffer_load_dwordx4 v[128:131], v2, s[12:15], s30 offen offset:3200 nt
    s_waitcnt vmcnt(5)
    buffer_load_dwordx4 v[132:135], v2, s[12:15], s30 offen offset:3328 nt
    s_waitcnt vmcnt(5)
    buffer_load_dwordx4 v[136:139], v3, s[12:15], s30 offen offset:0 nt
    s_waitcnt vmcnt(5)
    buffer_load_dwordx4 v[140:143], v3, s[12:15], s30 offen offset:128 nt
    s_waitcnt vmcnt(5)
    buffer_load_dwordx4 v[144:147], v3, s[12:15], s30 offen offset:256 nt
    s_waitcnt vmcnt(5)
    buffer_load_dwordx4 v[148:151], v3, s[12:15], s30 offen offset:3072 nt
    s_waitcnt vmcnt(5)
    buffer_load_dwordx4 v[152:155], v3, s[12:15], s30 offen offset:3200 nt
    s_waitcnt vmcnt(5)
    buffer_load_dwordx4 v[156:159], v3, s[12:15], s30 offen offset:3328 nt
    s_waitcnt vmcnt(5)
    buffer_load_dwordx4 v[160:163], v2, s[8:11], s31 offen offset:0 nt
    s_waitcnt vmcnt(5)
    buffer_load_dwordx4 v[164:167], v2, s[8:11], s31 offen offset:128 nt
    s_waitcnt vmcnt(5)
    buffer_load_dwordx4 v[168:171], v2, s[8:11], s31 offen offset:256 nt
    s_waitcnt vmcnt(5)
    buffer_load_dwordx4 v[172:175], v2, s[8:11], s31 offen offset:3072 nt
    s_waitcnt vmcnt(5)
    buffer_load_dwordx4 v[176:179], v2, s[8:11], s31 offen offset:3200 nt
    s_waitcnt vmcnt(5)
    buffer_load_dwordx4 v[180:183], v2, s[8:11], s31 offen offset:3328 nt
    s_waitcnt vmcnt(5)
    buffer_load_dwordx4 v[184:187], v3, s[8:11], s31 offen offset:0 nt
    s_waitcnt vmcnt(5)
    buffer_load_dwordx4 v[188:191], v3, s[8:11], s31 offen offset:128 nt
    s_waitcnt vmcnt(5)
    buffer_load_dwordx4 v[192:195], v3, s[8:11], s31 offen offset:256 nt
    s_waitcnt vmcnt(5)
    buffer_load_dwordx4 v[196:199], v3, s[8:11], s31 offen offset:3072 nt
    s_waitcnt vmcnt(5)
    buffer_load_dwordx4 v[200:203], v3, s[8:11], s31 offen offset:3200 nt
    s_waitcnt vmcnt(5)
    buffer_load_dwordx4 v[204:207], v3, s[8:11], s31 offen offset:3328 nt
    s_waitcnt vmcnt(5)
    buffer_load_dwordx4 v[208:211], v2, s[12:15], s31 offen offset:0 nt
    s_waitcnt vmcnt(5)
    buffer_load_dwordx4 v[212:215], v2, s[12:15], s31 offen offset:128 nt
    s_waitcnt vmcnt(5)
    buffer_load_dwordx4 v[216:219], v2, s[12:15], s31 offen offset:256 nt
    s_waitcnt vmcnt(5)
    buffer_load_dwordx4 v[220:223], v2, s[12:15], s31 offen offset:3072 nt
    s_waitcnt vmcnt(5)
    buffer_load_dwordx4 v[224:227], v2, s[12:15], s31 offen offset:3200 nt
    s_waitcnt vmcnt(5)
    buffer_load_dwordx4 v[228:231], v2, s[12:15], s31 offen offset:3328 nt
    s_waitcnt vmcnt(5)
    buffer_load_dwordx4 v[232:235], v3, s[12:15], s31 offen offset:0 nt
    s_waitcnt vmcnt(5)
    buffer_load_dwordx4 v[236:239], v3, s[12:15], s31 offen offset:128 nt
    s_waitcnt vmcnt(5)
    buffer_load_dwordx4 v[240:243], v3, s[12:15], s31 offen offset:256 nt
    s_waitcnt vmcnt(5)
    buffer_load_dwordx4 v[244:247], v3, s[12:15], s31 offen offset:3072 nt
    s_waitcnt vmcnt(5)
    buffer_load_dwordx4 v[248:251], v3, s[12:15], s31 offen offset:3200 nt
    s_waitcnt vmcnt(5)
    buffer_load_dwordx4 v[252:255], v3, s[12:15], s31 offen offset:3328 nt
    s_barrier
    v_and_b32 v56, 7, v1
    v_lshlrev_b32 v56, 4, v56
    ds_read_b128 v[4:7], v56 offset:64
    ds_read_b128 v[8:11], v56 offset:192
    ds_read_b128 v[12:15], v56 offset:320
    s_waitcnt lgkmcnt(0)
    s_and_b32 s20, s47, 0x7f7f7f7f
    s_add_u32 s20, s20, 0x6b2f593d
    s_xor_b32 s47, s47, 0x6b2f593d
    s_and_b32 s47, s47, 0x80808080
    s_xor_b32 s47, s47, s20
    s_and_b32 s20, s47, 0xff
    s_bfe_u32 s21, s47, 0x80008
    s_bfe_u32 s22, s47, 0x80010
    s_lshr_b32 s23, s47, 24
    v_dot2_f32_bf16 v40, v64, v4, 0
    v_dot2_f32_bf16 v41, v65, v5, 0
    v_dot2_f32_bf16 v40, v66, v6, v40
    v_dot2_f32_bf16 v41, v67, v7, v41
    buffer_load_dwordx4 v[64:67], v2, s[8:11], s32 offen offset:0 nt
    v_dot2_f32_bf16 v40, v68, v8, v40
    v_dot2_f32_bf16 v41, v69, v9, v41
    v_dot2_f32_bf16 v40, v70, v10, v40
    v_dot2_f32_bf16 v41, v71, v11, v41
    buffer_load_dwordx4 v[68:71], v2, s[8:11], s32 offen offset:128 nt
    v_dot2_f32_bf16 v40, v72, v12, v40
    v_dot2_f32_bf16 v41, v73, v13, v41
    v_dot2_f32_bf16 v40, v74, v14, v40
    v_dot2_f32_bf16 v41, v75, v15, v41
    buffer_load_dwordx4 v[72:75], v2, s[8:11], s32 offen offset:256 nt
    v_dot2_f32_bf16 v42, v76, v4, 0
    v_dot2_f32_bf16 v43, v77, v5, 0
    v_dot2_f32_bf16 v42, v78, v6, v42
    v_dot2_f32_bf16 v43, v79, v7, v43
    buffer_load_dwordx4 v[76:79], v2, s[8:11], s32 offen offset:3072 nt
    v_dot2_f32_bf16 v42, v80, v8, v42
    v_dot2_f32_bf16 v43, v81, v9, v43
    v_dot2_f32_bf16 v42, v82, v10, v42
    v_dot2_f32_bf16 v43, v83, v11, v43
    buffer_load_dwordx4 v[80:83], v2, s[8:11], s32 offen offset:3200 nt
    v_dot2_f32_bf16 v42, v84, v12, v42
    v_dot2_f32_bf16 v43, v85, v13, v43
    v_dot2_f32_bf16 v42, v86, v14, v42
    v_dot2_f32_bf16 v43, v87, v15, v43
    buffer_load_dwordx4 v[84:87], v2, s[8:11], s32 offen offset:3328 nt
    v_dot2_f32_bf16 v44, v88, v4, 0
    v_dot2_f32_bf16 v45, v89, v5, 0
    v_dot2_f32_bf16 v44, v90, v6, v44
    v_dot2_f32_bf16 v45, v91, v7, v45
    v_dot2_f32_bf16 v44, v92, v8, v44
    v_dot2_f32_bf16 v45, v93, v9, v45
    v_dot2_f32_bf16 v44, v94, v10, v44
    v_dot2_f32_bf16 v45, v95, v11, v45
    v_dot2_f32_bf16 v44, v96, v12, v44
    v_dot2_f32_bf16 v45, v97, v13, v45
    v_dot2_f32_bf16 v44, v98, v14, v44
    v_dot2_f32_bf16 v45, v99, v15, v45
    v_dot2_f32_bf16 v46, v100, v4, 0
    v_dot2_f32_bf16 v47, v101, v5, 0
    v_dot2_f32_bf16 v46, v102, v6, v46
    v_dot2_f32_bf16 v47, v103, v7, v47
    v_dot2_f32_bf16 v46, v104, v8, v46
    v_dot2_f32_bf16 v47, v105, v9, v47
    v_dot2_f32_bf16 v46, v106, v10, v46
    v_dot2_f32_bf16 v47, v107, v11, v47
    v_dot2_f32_bf16 v46, v108, v12, v46
    v_dot2_f32_bf16 v47, v109, v13, v47
    v_dot2_f32_bf16 v46, v110, v14, v46
    v_dot2_f32_bf16 v47, v111, v15, v47
    buffer_load_dwordx4 v[88:91], v3, s[8:11], s32 offen offset:0 nt
    v_add_f32 v36, v40, v41
    v_add_f32 v37, v42, v43
    v_add_f32 v38, v44, v45
    v_add_f32 v39, v46, v47
    v_add_f32_dpp v36, v36, v36 quad_perm:[1,0,3,2] row_mask:0xf bank_mask:0xf
    v_add_f32_dpp v37, v37, v37 quad_perm:[1,0,3,2] row_mask:0xf bank_mask:0xf
    v_add_f32_dpp v38, v38, v38 quad_perm:[1,0,3,2] row_mask:0xf bank_mask:0xf
    v_add_f32_dpp v39, v39, v39 quad_perm:[1,0,3,2] row_mask:0xf bank_mask:0xf
    v_add_f32_dpp v36, v36, v36 quad_perm:[2,3,0,1] row_mask:0xf bank_mask:0xf
    v_add_f32_dpp v37, v37, v37 quad_perm:[2,3,0,1] row_mask:0xf bank_mask:0xf
    v_add_f32_dpp v38, v38, v38 quad_perm:[2,3,0,1] row_mask:0xf bank_mask:0xf
    v_add_f32_dpp v39, v39, v39 quad_perm:[2,3,0,1] row_mask:0xf bank_mask:0xf
    v_add_f32_dpp v36, v36, v36 row_half_mirror row_mask:0xf bank_mask:0xf
    v_add_f32_dpp v37, v37, v37 row_half_mirror row_mask:0xf bank_mask:0xf
    v_add_f32_dpp v38, v38, v38 row_half_mirror row_mask:0xf bank_mask:0xf
    v_add_f32_dpp v39, v39, v39 row_half_mirror row_mask:0xf bank_mask:0xf
    v_cvt_pk_bf16_f32 v56, v36, v37
    v_cvt_pk_bf16_f32 v57, v38, v39
    v_lshlrev_b32 v36, 16, v56
    v_and_b32 v37, 0xffff0000, v56
    v_lshlrev_b32 v38, 16, v57
    v_and_b32 v39, 0xffff0000, v57
    v_mul_f32 v36, s34, v36
    v_mul_f32 v37, s34, v37
    v_mul_f32 v38, s34, v38
    v_mul_f32 v39, s34, v39
    v_cvt_pk_bf16_f32 v56, v36, v37
    v_cvt_pk_bf16_f32 v57, v38, v39
    v_lshlrev_b32 v36, 16, v56
    v_and_b32 v37, 0xffff0000, v56
    v_lshlrev_b32 v38, 16, v57
    v_and_b32 v39, 0xffff0000, v57
    v_max3_f32 v56, v36, v37, v38
    v_max_f32 v56, v56, v39
    v_cmp_gt_f32 vcc, v56, v32
    s_nop 0
    s_cbranch_vccz L_nomax1
    v_max_f32 v32, v56, v32
    s_nop 1
    v_max_f32_dpp v32, v32, v32 row_ror:8 row_mask:0xf bank_mask:0xf
    v_mov_b32 v57, v32
    s_nop 1
    v_permlane16_swap_b32 v32, v57
    v_max_f32 v32, v32, v57
    v_mov_b32 v57, v32
    s_nop 1
    v_permlane32_swap_b32 v32, v57
    v_max_f32 v32, v32, v57
    v_mul_f32 v56, s35, v32
    v_ceil_f32 v56, v56
    v_sub_f32 v57, v33, v56
    v_exp_f32 v57, v57
    v_mov_b32 v33, v56
    v_mul_f32 v20, v20, v57
    v_mul_f32 v21, v21, v57
    v_mul_f32 v22, v22, v57
    v_mul_f32 v23, v23, v57
    v_mul_f32 v24, v24, v57
    v_mul_f32 v25, v25, v57
    v_mul_f32 v26, v26, v57
    v_mul_f32 v27, v27, v57
    v_mul_f32 v28, v28, v57
    v_mul_f32 v29, v29, v57
    v_mul_f32 v30, v30, v57
    v_mul_f32 v31, v31, v57
    v_mul_f32 v34, v34, v57
L_nomax1:
    v_fma_f32 v36, v36, s35, -v33
    v_fma_f32 v37, v37, s35, -v33
    v_fma_f32 v38, v38, s35, -v33
    v_fma_f32 v39, v39, s35, -v33
    v_exp_f32 v36, v36
    v_exp_f32 v37, v37
    v_exp_f32 v38, v38
    v_exp_f32 v39, v39
    v_cvt_pk_bf16_f32 v56, v36, v36
    v_cvt_pk_bf16_f32 v57, v37, v37
    v_cvt_pk_bf16_f32 v58, v38, v38
    v_cvt_pk_bf16_f32 v59, v39, v39
    v_and_b32 v40, v56, v16
    v_and_b32 v41, v56, v17
    v_and_b32 v42, v56, v18
    v_and_b32 v43, v56, v19
    v_and_b32 v44, v57, v16
    v_and_b32 v45, v57, v17
    v_and_b32 v46, v57, v18
    v_and_b32 v47, v57, v19
    v_and_b32 v48, v58, v16
    v_and_b32 v49, v58, v17
    v_and_b32 v50, v58, v18
    v_and_b32 v51, v58, v19
    v_and_b32 v52, v59, v16
    v_and_b32 v53, v59, v17
    v_and_b32 v54, v59, v18
    v_and_b32 v55, v59, v19
    v_add_f32 v36, v36, v37
    v_add_f32 v38, v38, v39
    v_add_f32 v34, v34, v36
    v_add_f32 v34, v34, v38
    v_mfma_f32_16x16x32_bf16 v[20:23], v[112:115], v[40:43], v[20:23]
    v_mfma_f32_16x16x32_bf16 v[24:27], v[116:119], v[40:43], v[24:27]
    v_mfma_f32_16x16x32_bf16 v[28:31], v[120:123], v[40:43], v[28:31]
    v_mfma_f32_16x16x32_bf16 v[20:23], v[124:127], v[44:47], v[20:23]
    v_mfma_f32_16x16x32_bf16 v[24:27], v[128:131], v[44:47], v[24:27]
    v_mfma_f32_16x16x32_bf16 v[28:31], v[132:135], v[44:47], v[28:31]
    buffer_load_dwordx4 v[92:95], v3, s[8:11], s32 offen offset:128 nt
    v_mfma_f32_16x16x32_bf16 v[20:23], v[136:139], v[48:51], v[20:23]
    v_mfma_f32_16x16x32_bf16 v[24:27], v[140:143], v[48:51], v[24:27]
    v_mfma_f32_16x16x32_bf16 v[28:31], v[144:147], v[48:51], v[28:31]
    v_mfma_f32_16x16x32_bf16 v[20:23], v[148:151], v[52:55], v[20:23]
    v_mfma_f32_16x16x32_bf16 v[24:27], v[152:155], v[52:55], v[24:27]
    v_mfma_f32_16x16x32_bf16 v[28:31], v[156:159], v[52:55], v[28:31]
    buffer_load_dwordx4 v[96:99], v3, s[8:11], s32 offen offset:256 nt
    v_dot2_f32_bf16 v40, v160, v4, 0
    v_dot2_f32_bf16 v41, v161, v5, 0
    v_dot2_f32_bf16 v40, v162, v6, v40
    v_dot2_f32_bf16 v41, v163, v7, v41
    v_dot2_f32_bf16 v40, v164, v8, v40
    v_dot2_f32_bf16 v41, v165, v9, v41
    v_dot2_f32_bf16 v40, v166, v10, v40
    v_dot2_f32_bf16 v41, v167, v11, v41
    v_dot2_f32_bf16 v40, v168, v12, v40
    v_dot2_f32_bf16 v41, v169, v13, v41
    v_dot2_f32_bf16 v40, v170, v14, v40
    v_dot2_f32_bf16 v41, v171, v15, v41
    v_dot2_f32_bf16 v42, v172, v4, 0
    v_dot2_f32_bf16 v43, v173, v5, 0
    v_dot2_f32_bf16 v42, v174, v6, v42
    v_dot2_f32_bf16 v43, v175, v7, v43
    v_dot2_f32_bf16 v42, v176, v8, v42
    v_dot2_f32_bf16 v43, v177, v9, v43
    v_dot2_f32_bf16 v42, v178, v10, v42
    v_dot2_f32_bf16 v43, v179, v11, v43
    v_dot2_f32_bf16 v42, v180, v12, v42
    v_dot2_f32_bf16 v43, v181, v13, v43
    v_dot2_f32_bf16 v42, v182, v14, v42
    v_dot2_f32_bf16 v43, v183, v15, v43
    buffer_load_dwordx4 v[100:103], v3, s[8:11], s32 offen offset:3072 nt
    v_dot2_f32_bf16 v44, v184, v4, 0
    v_dot2_f32_bf16 v45, v185, v5, 0
    v_dot2_f32_bf16 v44, v186, v6, v44
    v_dot2_f32_bf16 v45, v187, v7, v45
    v_dot2_f32_bf16 v44, v188, v8, v44
    v_dot2_f32_bf16 v45, v189, v9, v45
    v_dot2_f32_bf16 v44, v190, v10, v44
    v_dot2_f32_bf16 v45, v191, v11, v45
    v_dot2_f32_bf16 v44, v192, v12, v44
    v_dot2_f32_bf16 v45, v193, v13, v45
    v_dot2_f32_bf16 v44, v194, v14, v44
    v_dot2_f32_bf16 v45, v195, v15, v45
    v_dot2_f32_bf16 v46, v196, v4, 0
    v_dot2_f32_bf16 v47, v197, v5, 0
    v_dot2_f32_bf16 v46, v198, v6, v46
    v_dot2_f32_bf16 v47, v199, v7, v47
    v_dot2_f32_bf16 v46, v200, v8, v46
    v_dot2_f32_bf16 v47, v201, v9, v47
    v_dot2_f32_bf16 v46, v202, v10, v46
    v_dot2_f32_bf16 v47, v203, v11, v47
    v_dot2_f32_bf16 v46, v204, v12, v46
    v_dot2_f32_bf16 v47, v205, v13, v47
    v_dot2_f32_bf16 v46, v206, v14, v46
    v_dot2_f32_bf16 v47, v207, v15, v47
    buffer_load_dwordx4 v[104:107], v3, s[8:11], s32 offen offset:3200 nt
    v_add_f32 v36, v40, v41
    v_add_f32 v37, v42, v43
    v_add_f32 v38, v44, v45
    v_add_f32 v39, v46, v47
    v_add_f32_dpp v36, v36, v36 quad_perm:[1,0,3,2] row_mask:0xf bank_mask:0xf
    v_add_f32_dpp v37, v37, v37 quad_perm:[1,0,3,2] row_mask:0xf bank_mask:0xf
    v_add_f32_dpp v38, v38, v38 quad_perm:[1,0,3,2] row_mask:0xf bank_mask:0xf
    v_add_f32_dpp v39, v39, v39 quad_perm:[1,0,3,2] row_mask:0xf bank_mask:0xf
    v_add_f32_dpp v36, v36, v36 quad_perm:[2,3,0,1] row_mask:0xf bank_mask:0xf
    v_add_f32_dpp v37, v37, v37 quad_perm:[2,3,0,1] row_mask:0xf bank_mask:0xf
    v_add_f32_dpp v38, v38, v38 quad_perm:[2,3,0,1] row_mask:0xf bank_mask:0xf
    v_add_f32_dpp v39, v39, v39 quad_perm:[2,3,0,1] row_mask:0xf bank_mask:0xf
    v_add_f32_dpp v36, v36, v36 row_half_mirror row_mask:0xf bank_mask:0xf
    v_add_f32_dpp v37, v37, v37 row_half_mirror row_mask:0xf bank_mask:0xf
    v_add_f32_dpp v38, v38, v38 row_half_mirror row_mask:0xf bank_mask:0xf
    v_add_f32_dpp v39, v39, v39 row_half_mirror row_mask:0xf bank_mask:0xf
    v_cvt_pk_bf16_f32 v56, v36, v37
    v_cvt_pk_bf16_f32 v57, v38, v39
    v_lshlrev_b32 v36, 16, v56
    v_and_b32 v37, 0xffff0000, v56
    v_lshlrev_b32 v38, 16, v57
    v_and_b32 v39, 0xffff0000, v57
    v_mul_f32 v36, s34, v36
    v_mul_f32 v37, s34, v37
    v_mul_f32 v38, s34, v38
    v_mul_f32 v39, s34, v39
    v_cvt_pk_bf16_f32 v56, v36, v37
    v_cvt_pk_bf16_f32 v57, v38, v39
    v_lshlrev_b32 v36, 16, v56
    v_and_b32 v37, 0xffff0000, v56
    v_lshlrev_b32 v38, 16, v57
    v_and_b32 v39, 0xffff0000, v57
    v_max3_f32 v56, v36, v37, v38
    v_max_f32 v56, v56, v39
    v_cmp_gt_f32 vcc, v56, v32
    s_nop 0
    s_cbranch_vccz L_nomax2
    v_max_f32 v32, v56, v32
    s_nop 1
    v_max_f32_dpp v32, v32, v32 row_ror:8 row_mask:0xf bank_mask:0xf
    v_mov_b32 v57, v32
    s_nop 1
    v_permlane16_swap_b32 v32, v57
    v_max_f32 v32, v32, v57
    v_mov_b32 v57, v32
    s_nop 1
    v_permlane32_swap_b32 v32, v57
    v_max_f32 v32, v32, v57
    v_mul_f32 v56, s35, v32
    v_ceil_f32 v56, v56
    v_sub_f32 v57, v33, v56
    v_exp_f32 v57, v57
    v_mov_b32 v33, v56
    v_mul_f32 v20, v20, v57
    v_mul_f32 v21, v21, v57
    v_mul_f32 v22, v22, v57
    v_mul_f32 v23, v23, v57
    v_mul_f32 v24, v24, v57
    v_mul_f32 v25, v25, v57
    v_mul_f32 v26, v26, v57
    v_mul_f32 v27, v27, v57
    v_mul_f32 v28, v28, v57
    v_mul_f32 v29, v29, v57
    v_mul_f32 v30, v30, v57
    v_mul_f32 v31, v31, v57
    v_mul_f32 v34, v34, v57
L_nomax2:
    v_fma_f32 v36, v36, s35, -v33
    v_fma_f32 v37, v37, s35, -v33
    v_fma_f32 v38, v38, s35, -v33
    v_fma_f32 v39, v39, s35, -v33
    v_exp_f32 v36, v36
    v_exp_f32 v37, v37
    v_exp_f32 v38, v38
    v_exp_f32 v39, v39
    v_cvt_pk_bf16_f32 v56, v36, v36
    v_cvt_pk_bf16_f32 v57, v37, v37
    v_cvt_pk_bf16_f32 v58, v38, v38
    v_cvt_pk_bf16_f32 v59, v39, v39
    v_and_b32 v40, v56, v16
    v_and_b32 v41, v56, v17
    v_and_b32 v42, v56, v18
    v_and_b32 v43, v56, v19
    v_and_b32 v44, v57, v16
    v_and_b32 v45, v57, v17
    v_and_b32 v46, v57, v18
    v_and_b32 v47, v57, v19
    v_and_b32 v48, v58, v16
    v_and_b32 v49, v58, v17
    v_and_b32 v50, v58, v18
    v_and_b32 v51, v58, v19
    v_and_b32 v52, v59, v16
    v_and_b32 v53, v59, v17
    v_and_b32 v54, v59, v18
    v_and_b32 v55, v59, v19
    v_add_f32 v36, v36, v37
    v_add_f32 v38, v38, v39
    v_add_f32 v34, v34, v36
    v_add_f32 v34, v34, v38
    v_mfma_f32_16x16x32_bf16 v[20:23], v[208:211], v[40:43], v[20:23]
    v_mfma_f32_16x16x32_bf16 v[24:27], v[212:215], v[40:43], v[24:27]
    v_mfma_f32_16x16x32_bf16 v[28:31], v[216:219], v[40:43], v[28:31]
    v_mfma_f32_16x16x32_bf16 v[20:23], v[220:223], v[44:47], v[20:23]
    v_mfma_f32_16x16x32_bf16 v[24:27], v[224:227], v[44:47], v[24:27]
    v_mfma_f32_16x16x32_bf16 v[28:31], v[228:231], v[44:47], v[28:31]
    buffer_load_dwordx4 v[108:111], v3, s[8:11], s32 offen offset:3328 nt
    s_waitcnt vmcnt(17)
    v_mfma_f32_16x16x32_bf16 v[20:23], v[232:235], v[48:51], v[20:23]
    s_waitcnt vmcnt(16)
    v_mfma_f32_16x16x32_bf16 v[24:27], v[236:239], v[48:51], v[24:27]
    s_waitcnt vmcnt(15)
    v_mfma_f32_16x16x32_bf16 v[28:31], v[240:243], v[48:51], v[28:31]
    s_waitcnt vmcnt(14)
    v_mfma_f32_16x16x32_bf16 v[20:23], v[244:247], v[52:55], v[20:23]
    s_waitcnt vmcnt(13)
    v_mfma_f32_16x16x32_bf16 v[24:27], v[248:251], v[52:55], v[24:27]
    s_waitcnt vmcnt(12)
    v_mfma_f32_16x16x32_bf16 v[28:31], v[252:255], v[52:55], v[28:31]
    buffer_load_dwordx4 v[112:115], v2, s[12:15], s32 offen offset:0 nt
    s_waitcnt vmcnt(12)
    v_dot2_f32_bf16 v40, v64, v4, 0
    v_dot2_f32_bf16 v41, v65, v5, 0
    v_dot2_f32_bf16 v40, v66, v6, v40
    v_dot2_f32_bf16 v41, v67, v7, v41
    s_waitcnt vmcnt(11)
    v_dot2_f32_bf16 v40, v68, v8, v40
    v_dot2_f32_bf16 v41, v69, v9, v41
    v_dot2_f32_bf16 v40, v70, v10, v40
    v_dot2_f32_bf16 v41, v71, v11, v41
    s_waitcnt vmcnt(10)
    v_dot2_f32_bf16 v40, v72, v12, v40
    v_dot2_f32_bf16 v41, v73, v13, v41
    v_dot2_f32_bf16 v40, v74, v14, v40
    v_dot2_f32_bf16 v41, v75, v15, v41
    s_waitcnt vmcnt(9)
    v_dot2_f32_bf16 v42, v76, v4, 0
    v_dot2_f32_bf16 v43, v77, v5, 0
    v_dot2_f32_bf16 v42, v78, v6, v42
    v_dot2_f32_bf16 v43, v79, v7, v43
    s_waitcnt vmcnt(8)
    v_dot2_f32_bf16 v42, v80, v8, v42
    v_dot2_f32_bf16 v43, v81, v9, v43
    v_dot2_f32_bf16 v42, v82, v10, v42
    v_dot2_f32_bf16 v43, v83, v11, v43
    s_waitcnt vmcnt(7)
    v_dot2_f32_bf16 v42, v84, v12, v42
    v_dot2_f32_bf16 v43, v85, v13, v43
    v_dot2_f32_bf16 v42, v86, v14, v42
    v_dot2_f32_bf16 v43, v87, v15, v43
    s_waitcnt vmcnt(6)
    v_dot2_f32_bf16 v44, v88, v4, 0
    v_dot2_f32_bf16 v45, v89, v5, 0
    v_dot2_f32_bf16 v44, v90, v6, v44
    v_dot2_f32_bf16 v45, v91, v7, v45
    s_waitcnt vmcnt(5)
    buffer_load_dwordx4 v[116:119], v2, s[12:15], s32 offen offset:128 nt
    v_dot2_f32_bf16 v44, v92, v8, v44
    v_dot2_f32_bf16 v45, v93, v9, v45
    v_dot2_f32_bf16 v44, v94, v10, v44
    v_dot2_f32_bf16 v45, v95, v11, v45
    s_waitcnt vmcnt(5)
    buffer_load_dwordx4 v[120:123], v2, s[12:15], s32 offen offset:256 nt
    v_dot2_f32_bf16 v44, v96, v12, v44
    v_dot2_f32_bf16 v45, v97, v13, v45
    v_dot2_f32_bf16 v44, v98, v14, v44
    v_dot2_f32_bf16 v45, v99, v15, v45
    s_waitcnt vmcnt(5)
    buffer_load_dwordx4 v[124:127], v2, s[12:15], s32 offen offset:3072 nt
    v_dot2_f32_bf16 v46, v100, v4, 0
    v_dot2_f32_bf16 v47, v101, v5, 0
    v_dot2_f32_bf16 v46, v102, v6, v46
    v_dot2_f32_bf16 v47, v103, v7, v47
    s_waitcnt vmcnt(5)
    buffer_load_dwordx4 v[128:131], v2, s[12:15], s32 offen offset:3200 nt
    v_dot2_f32_bf16 v46, v104, v8, v46
    v_dot2_f32_bf16 v47, v105, v9, v47
    v_dot2_f32_bf16 v46, v106, v10, v46
    v_dot2_f32_bf16 v47, v107, v11, v47
    s_waitcnt vmcnt(5)
    buffer_load_dwordx4 v[132:135], v2, s[12:15], s32 offen offset:3328 nt
    v_dot2_f32_bf16 v46, v108, v12, v46
    v_dot2_f32_bf16 v47, v109, v13, v47
    v_dot2_f32_bf16 v46, v110, v14, v46
    v_dot2_f32_bf16 v47, v111, v15, v47
    v_add_f32 v36, v40, v41
    v_add_f32 v37, v42, v43
    v_add_f32 v38, v44, v45
    v_add_f32 v39, v46, v47
    v_add_f32_dpp v36, v36, v36 quad_perm:[1,0,3,2] row_mask:0xf bank_mask:0xf
    v_add_f32_dpp v37, v37, v37 quad_perm:[1,0,3,2] row_mask:0xf bank_mask:0xf
    v_add_f32_dpp v38, v38, v38 quad_perm:[1,0,3,2] row_mask:0xf bank_mask:0xf
    v_add_f32_dpp v39, v39, v39 quad_perm:[1,0,3,2] row_mask:0xf bank_mask:0xf
    v_add_f32_dpp v36, v36, v36 quad_perm:[2,3,0,1] row_mask:0xf bank_mask:0xf
    v_add_f32_dpp v37, v37, v37 quad_perm:[2,3,0,1] row_mask:0xf bank_mask:0xf
    v_add_f32_dpp v38, v38, v38 quad_perm:[2,3,0,1] row_mask:0xf bank_mask:0xf
    v_add_f32_dpp v39, v39, v39 quad_perm:[2,3,0,1] row_mask:0xf bank_mask:0xf
    v_add_f32_dpp v36, v36, v36 row_half_mirror row_mask:0xf bank_mask:0xf
    v_add_f32_dpp v37, v37, v37 row_half_mirror row_mask:0xf bank_mask:0xf
    v_add_f32_dpp v38, v38, v38 row_half_mirror row_mask:0xf bank_mask:0xf
    v_add_f32_dpp v39, v39, v39 row_half_mirror row_mask:0xf bank_mask:0xf
    v_cvt_pk_bf16_f32 v56, v36, v37
    v_cvt_pk_bf16_f32 v57, v38, v39
    v_lshlrev_b32 v36, 16, v56
    v_and_b32 v37, 0xffff0000, v56
    v_lshlrev_b32 v38, 16, v57
    v_and_b32 v39, 0xffff0000, v57
    v_mul_f32 v36, s34, v36
    v_mul_f32 v37, s34, v37
    v_mul_f32 v38, s34, v38
    v_mul_f32 v39, s34, v39
    v_cvt_pk_bf16_f32 v56, v36, v37
    v_cvt_pk_bf16_f32 v57, v38, v39
    v_lshlrev_b32 v36, 16, v56
    v_and_b32 v37, 0xffff0000, v56
    v_lshlrev_b32 v38, 16, v57
    v_and_b32 v39, 0xffff0000, v57
    v_max3_f32 v56, v36, v37, v38
    v_max_f32 v56, v56, v39
    v_cmp_gt_f32 vcc, v56, v32
    s_nop 0
    s_cbranch_vccz L_nomax3
    v_max_f32 v32, v56, v32
    s_nop 1
    v_max_f32_dpp v32, v32, v32 row_ror:8 row_mask:0xf bank_mask:0xf
    v_mov_b32 v57, v32
    s_nop 1
    v_permlane16_swap_b32 v32, v57
    v_max_f32 v32, v32, v57
    v_mov_b32 v57, v32
    s_nop 1
    v_permlane32_swap_b32 v32, v57
    v_max_f32 v32, v32, v57
    v_mul_f32 v56, s35, v32
    v_ceil_f32 v56, v56
    v_sub_f32 v57, v33, v56
    v_exp_f32 v57, v57
    v_mov_b32 v33, v56
    v_mul_f32 v20, v20, v57
    v_mul_f32 v21, v21, v57
    v_mul_f32 v22, v22, v57
    v_mul_f32 v23, v23, v57
    v_mul_f32 v24, v24, v57
    v_mul_f32 v25, v25, v57
    v_mul_f32 v26, v26, v57
    v_mul_f32 v27, v27, v57
    v_mul_f32 v28, v28, v57
    v_mul_f32 v29, v29, v57
    v_mul_f32 v30, v30, v57
    v_mul_f32 v31, v31, v57
    v_mul_f32 v34, v34, v57
L_nomax3:
    v_fma_f32 v36, v36, s35, -v33
    v_fma_f32 v37, v37, s35, -v33
    v_fma_f32 v38, v38, s35, -v33
    v_fma_f32 v39, v39, s35, -v33
    v_exp_f32 v36, v36
    v_exp_f32 v37, v37
    v_exp_f32 v38, v38
    v_exp_f32 v39, v39
    v_cvt_pk_bf16_f32 v56, v36, v36
    v_cvt_pk_bf16_f32 v57, v37, v37
    v_cvt_pk_bf16_f32 v58, v38, v38
    v_cvt_pk_bf16_f32 v59, v39, v39
    v_and_b32 v40, v56, v16
    v_and_b32 v41, v56, v17
    v_and_b32 v42, v56, v18
    v_and_b32 v43, v56, v19
    v_and_b32 v44, v57, v16
    v_and_b32 v45, v57, v17
    v_and_b32 v46, v57, v18
    v_and_b32 v47, v57, v19
    v_and_b32 v48, v58, v16
    v_and_b32 v49, v58, v17
    v_and_b32 v50, v58, v18
    v_and_b32 v51, v58, v19
    v_and_b32 v52, v59, v16
    v_and_b32 v53, v59, v17
    v_and_b32 v54, v59, v18
    v_and_b32 v55, v59, v19
    v_add_f32 v36, v36, v37
    v_add_f32 v38, v38, v39
    v_add_f32 v34, v34, v36
    v_add_f32 v34, v34, v38
    s_waitcnt vmcnt(5)
    buffer_load_dwordx4 v[136:139], v3, s[12:15], s32 offen offset:0 nt
    v_mfma_f32_16x16x32_bf16 v[20:23], v[112:115], v[40:43], v[20:23]
    s_waitcnt vmcnt(5)
    buffer_load_dwordx4 v[140:143], v3, s[12:15], s32 offen offset:128 nt
    v_mfma_f32_16x16x32_bf16 v[24:27], v[116:119], v[40:43], v[24:27]
    s_waitcnt vmcnt(5)
    buffer_load_dwordx4 v[144:147], v3, s[12:15], s32 offen offset:256 nt
    v_mfma_f32_16x16x32_bf16 v[28:31], v[120:123], v[40:43], v[28:31]
    s_waitcnt vmcnt(5)
    buffer_load_dwordx4 v[148:151], v3, s[12:15], s32 offen offset:3072 nt
    v_mfma_f32_16x16x32_bf16 v[20:23], v[124:127], v[44:47], v[20:23]
    s_waitcnt vmcnt(5)
    buffer_load_dwordx4 v[152:155], v3, s[12:15], s32 offen offset:3200 nt
    v_mfma_f32_16x16x32_bf16 v[24:27], v[128:131], v[44:47], v[24:27]
    s_waitcnt vmcnt(5)
    buffer_load_dwordx4 v[156:159], v3, s[12:15], s32 offen offset:3328 nt
    v_mfma_f32_16x16x32_bf16 v[28:31], v[132:135], v[44:47], v[28:31]
    s_waitcnt vmcnt(5)
    buffer_load_dwordx4 v[64:67], v2, s[8:11], s33 offen offset:0 nt
    v_mfma_f32_16x16x32_bf16 v[20:23], v[136:139], v[48:51], v[20:23]
    s_waitcnt vmcnt(5)
    buffer_load_dwordx4 v[68:71], v2, s[8:11], s33 offen offset:128 nt
    v_mfma_f32_16x16x32_bf16 v[24:27], v[140:143], v[48:51], v[24:27]
    s_waitcnt vmcnt(5)
    buffer_load_dwordx4 v[72:75], v2, s[8:11], s33 offen offset:256 nt
    v_mfma_f32_16x16x32_bf16 v[28:31], v[144:147], v[48:51], v[28:31]
    s_waitcnt vmcnt(5)
    buffer_load_dwordx4 v[76:79], v2, s[8:11], s33 offen offset:3072 nt
    v_mfma_f32_16x16x32_bf16 v[20:23], v[148:151], v[52:55], v[20:23]
    s_waitcnt vmcnt(5)
    buffer_load_dwordx4 v[80:83], v2, s[8:11], s33 offen offset:3200 nt
    v_mfma_f32_16x16x32_bf16 v[24:27], v[152:155], v[52:55], v[24:27]
    s_waitcnt vmcnt(5)
    buffer_load_dwordx4 v[84:87], v2, s[8:11], s33 offen offset:3328 nt
    v_mfma_f32_16x16x32_bf16 v[28:31], v[156:159], v[52:55], v[28:31]
    s_mov_b32 s30, s33
    s_mov_b32 s39, 3
L_loop:
    s_cmp_lg_u32 s39, 8
    s_nop 3
    s_cbranch_scc1 L_noswitch
    v_add_f32_dpp v34, v34, v34 row_ror:8 row_mask:0xf bank_mask:0xf
    v_mov_b32 v56, v34
    s_nop 1
    v_permlane16_swap_b32 v34, v56
    v_add_f32 v34, v34, v56
    v_mov_b32 v56, v34
    s_nop 1
    v_permlane32_swap_b32 v34, v56
    v_add_f32 v34, v34, v56
    v_mov_b32 v56, v33
    v_mov_b32 v57, v34
    s_lshl_b32 s38, s3, 3
    v_mov_b32 v58, s38
    s_mov_b64 exec, 1
    ds_write_b64 v58, v[56:57] offset:896
    s_mov_b64 exec, -1
    v_lshrrev_b32 v59, 5, v1
    v_mul_u32_u24 v59, 768, v59
    v_bfe_u32 v60, v1, 4, 1
    v_lshl_add_u32 v59, v60, 7, v59
    v_and_b32 v60, 7, v1
    v_lshl_add_u32 v59, v60, 4, v59
    s_mul_i32 s38, s3, 1536
    v_add_u32 v59, s38, v59
    s_mov_b32 exec_lo, 0x00ff00ff
    s_mov_b32 exec_hi, 0xff00ff00
    ds_write_b128 v59, v[20:23] offset:8192
    ds_write_b128 v59, v[24:27] offset:8448
    ds_write_b128 v59, v[28:31] offset:8704
    s_mov_b64 exec, -1
    v_mov_b32 v56, 0
    v_mov_b32 v57, 1
    s_mov_b64 exec, 1
    ds_add_u32 v56, v57 offset:16
    s_mov_b64 exec, -1
    v_and_b32 v56, 7, v1
    v_lshlrev_b32 v56, 4, v56
    ds_read_b128 v[4:7], v56 offset:448
    ds_read_b128 v[8:11], v56 offset:576
    ds_read_b128 v[12:15], v56 offset:704
    s_waitcnt lgkmcnt(0)
    v_mov_b32 v20, 0
    v_mov_b32 v21, 0
    v_mov_b32 v22, 0
    v_mov_b32 v23, 0
    v_mov_b32 v24, 0
    v_mov_b32 v25, 0
    v_mov_b32 v26, 0
    v_mov_b32 v27, 0
    v_mov_b32 v28, 0
    v_mov_b32 v29, 0
    v_mov_b32 v30, 0
    v_mov_b32 v31, 0
    v_mov_b32 v32, 0xff800000
    v_mov_b32 v33, 0xff800000
    v_mov_b32 v34, 0
L_noswitch:
    s_add_u32 s45, s45, 1
    s_cmp_eq_u32 s45, s46
    s_cselect_b32 s45, 0, s45
    s_cmp_eq_u32 s39, 7
    s_cselect_b32 s44, s36, s44
    s_cselect_b32 s46, 4, s46
    s_cselect_b32 s45, s42, s45
    s_mul_i32 s31, s45, 393216
    s_add_u32 s31, s31, s44
    s_waitcnt vmcnt(5)
    buffer_load_dwordx4 v[88:91], v3, s[8:11], s30 offen offset:0 nt
    v_dot2_f32_bf16 v40, v64, v4, 0
    v_dot2_f32_bf16 v41, v65, v5, 0
    v_dot2_f32_bf16 v40, v66, v6, v40
    v_dot2_f32_bf16 v41, v67, v7, v41
    s_waitcnt vmcnt(5)
    buffer_load_dwordx4 v[92:95], v3, s[8:11], s30 offen offset:128 nt
    v_dot2_f32_bf16 v40, v68, v8, v40
    v_dot2_f32_bf16 v41, v69, v9, v41
    v_dot2_f32_bf16 v40, v70, v10, v40
    v_dot2_f32_bf16 v41, v71, v11, v41
    s_waitcnt vmcnt(5)
    buffer_load_dwordx4 v[96:99], v3, s[8:11], s30 offen offset:256 nt
    v_dot2_f32_bf16 v40, v72, v12, v40
    v_dot2_f32_bf16 v41, v73, v13, v41
    v_dot2_f32_bf16 v40, v74, v14, v40
    v_dot2_f32_bf16 v41, v75, v15, v41
    s_waitcnt vmcnt(5)
    buffer_load_dwordx4 v[100:103], v3, s[8:11], s30 offen offset:3072 nt
    v_dot2_f32_bf16 v42, v76, v4, 0
    v_dot2_f32_bf16 v43, v77, v5, 0
    v_dot2_f32_bf16 v42, v78, v6, v42
    v_dot2_f32_bf16 v43, v79, v7, v43
    s_waitcnt vmcnt(5)
    buffer_load_dwordx4 v[104:107], v3, s[8:11], s30 offen offset:3200 nt
    v_dot2_f32_bf16 v42, v80, v8, v42
    v_dot2_f32_bf16 v43, v81, v9, v43
    v_dot2_f32_bf16 v42, v82, v10, v42
    v_dot2_f32_bf16 v43, v83, v11, v43
    s_waitcnt vmcnt(5)
    buffer_load_dwordx4 v[108:111], v3, s[8:11], s30 offen offset:3328 nt
    v_dot2_f32_bf16 v42, v84, v12, v42
    v_dot2_f32_bf16 v43, v85, v13, v43
    v_dot2_f32_bf16 v42, v86, v14, v42
    v_dot2_f32_bf16 v43, v87, v15, v43
    s_waitcnt vmcnt(5)
    buffer_load_dwordx4 v[112:115], v2, s[12:15], s30 offen offset:0 nt
    v_dot2_f32_bf16 v44, v88, v4, 0
    v_dot2_f32_bf16 v45, v89, v5, 0
    v_dot2_f32_bf16 v44, v90, v6, v44
    v_dot2_f32_bf16 v45, v91, v7, v45
    s_waitcnt vmcnt(5)
    buffer_load_dwordx4 v[116:119], v2, s[12:15], s30 offen offset:128 nt
    v_dot2_f32_bf16 v44, v92, v8, v44
    v_dot2_f32_bf16 v45, v93, v9, v45
    v_dot2_f32_bf16 v44, v94, v10, v44
    v_dot2_f32_bf16 v45, v95, v11, v45
    s_waitcnt vmcnt(5)
    buffer_load_dwordx4 v[120:123], v2, s[12:15], s30 offen offset:256 nt
    v_dot2_f32_bf16 v44, v96, v12, v44
    v_dot2_f32_bf16 v45, v97, v13, v45
    v_dot2_f32_bf16 v44, v98, v14, v44
    v_dot2_f32_bf16 v45, v99, v15, v45
    s_waitcnt vmcnt(5)
    buffer_load_dwordx4 v[124:127], v2, s[12:15], s30 offen offset:3072 nt
    v_dot2_f32_bf16 v46, v100, v4, 0
    v_dot2_f32_bf16 v47, v101, v5, 0
    v_dot2_f32_bf16 v46, v102, v6, v46
    v_dot2_f32_bf16 v47, v103, v7, v47
    s_waitcnt vmcnt(5)
    buffer_load_dwordx4 v[128:131], v2, s[12:15], s30 offen offset:3200 nt
    v_dot2_f32_bf16 v46, v104, v8, v46
    v_dot2_f32_bf16 v47, v105, v9, v47
    v_dot2_f32_bf16 v46, v106, v10, v46
    v_dot2_f32_bf16 v47, v107, v11, v47
    s_waitcnt vmcnt(5)
    buffer_load_dwordx4 v[132:135], v2, s[12:15], s30 offen offset:3328 nt
    v_dot2_f32_bf16 v46, v108, v12, v46
    v_dot2_f32_bf16 v47, v109, v13, v47
    v_dot2_f32_bf16 v46, v110, v14, v46
    v_dot2_f32_bf16 v47, v111, v15, v47
    v_add_f32 v36, v40, v41
    v_add_f32 v37, v42, v43
    v_add_f32 v38, v44, v45
    v_add_f32 v39, v46, v47
    v_add_f32_dpp v36, v36, v36 quad_perm:[1,0,3,2] row_mask:0xf bank_mask:0xf
    v_add_f32_dpp v37, v37, v37 quad_perm:[1,0,3,2] row_mask:0xf bank_mask:0xf
    v_add_f32_dpp v38, v38, v38 quad_perm:[1,0,3,2] row_mask:0xf bank_mask:0xf
    v_add_f32_dpp v39, v39, v39 quad_perm:[1,0,3,2] row_mask:0xf bank_mask:0xf
    v_add_f32_dpp v36, v36, v36 quad_perm:[2,3,0,1] row_mask:0xf bank_mask:0xf
    v_add_f32_dpp v37, v37, v37 quad_perm:[2,3,0,1] row_mask:0xf bank_mask:0xf
    v_add_f32_dpp v38, v38, v38 quad_perm:[2,3,0,1] row_mask:0xf bank_mask:0xf
    v_add_f32_dpp v39, v39, v39 quad_perm:[2,3,0,1] row_mask:0xf bank_mask:0xf
    v_add_f32_dpp v36, v36, v36 row_half_mirror row_mask:0xf bank_mask:0xf
    v_add_f32_dpp v37, v37, v37 row_half_mirror row_mask:0xf bank_mask:0xf
    v_add_f32_dpp v38, v38, v38 row_half_mirror row_mask:0xf bank_mask:0xf
    v_add_f32_dpp v39, v39, v39 row_half_mirror row_mask:0xf bank_mask:0xf
    v_cvt_pk_bf16_f32 v56, v36, v37
    v_cvt_pk_bf16_f32 v57, v38, v39
    v_lshlrev_b32 v36, 16, v56
    v_and_b32 v37, 0xffff0000, v56
    v_lshlrev_b32 v38, 16, v57
    v_and_b32 v39, 0xffff0000, v57
    v_mul_f32 v36, s34, v36
    v_mul_f32 v37, s34, v37
    v_mul_f32 v38, s34, v38
    v_mul_f32 v39, s34, v39
    v_cvt_pk_bf16_f32 v56, v36, v37
    v_cvt_pk_bf16_f32 v57, v38, v39
    v_lshlrev_b32 v36, 16, v56
    v_and_b32 v37, 0xffff0000, v56
    v_lshlrev_b32 v38, 16, v57
    v_and_b32 v39, 0xffff0000, v57
    v_max3_f32 v56, v36, v37, v38
    v_max_f32 v56, v56, v39
    v_cmp_gt_f32 vcc, v56, v32
    s_nop 0
    s_cbranch_vccz L_nomax4
    v_max_f32 v32, v56, v32
    s_nop 1
    v_max_f32_dpp v32, v32, v32 row_ror:8 row_mask:0xf bank_mask:0xf
    v_mov_b32 v57, v32
    s_nop 1
    v_permlane16_swap_b32 v32, v57
    v_max_f32 v32, v32, v57
    v_mov_b32 v57, v32
    s_nop 1
    v_permlane32_swap_b32 v32, v57
    v_max_f32 v32, v32, v57
    v_mul_f32 v56, s35, v32
    v_ceil_f32 v56, v56
    v_sub_f32 v57, v33, v56
    v_exp_f32 v57, v57
    v_mov_b32 v33, v56
    v_mul_f32 v20, v20, v57
    v_mul_f32 v21, v21, v57
    v_mul_f32 v22, v22, v57
    v_mul_f32 v23, v23, v57
    v_mul_f32 v24, v24, v57
    v_mul_f32 v25, v25, v57
    v_mul_f32 v26, v26, v57
    v_mul_f32 v27, v27, v57
    v_mul_f32 v28, v28, v57
    v_mul_f32 v29, v29, v57
    v_mul_f32 v30, v30, v57
    v_mul_f32 v31, v31, v57
    v_mul_f32 v34, v34, v57
L_nomax4:
    v_fma_f32 v36, v36, s35, -v33
    v_fma_f32 v37, v37, s35, -v33
    v_fma_f32 v38, v38, s35, -v33
    v_fma_f32 v39, v39, s35, -v33
    v_exp_f32 v36, v36
    v_exp_f32 v37, v37
    v_exp_f32 v38, v38
    v_exp_f32 v39, v39
    v_cvt_pk_bf16_f32 v56, v36, v36
    v_cvt_pk_bf16_f32 v57, v37, v37
    v_cvt_pk_bf16_f32 v58, v38, v38
    v_cvt_pk_bf16_f32 v59, v39, v39
    v_and_b32 v40, v56, v16
    v_and_b32 v41, v56, v17
    v_and_b32 v42, v56, v18
    v_and_b32 v43, v56, v19
    v_and_b32 v44, v57, v16
    v_and_b32 v45, v57, v17
    v_and_b32 v46, v57, v18
    v_and_b32 v47, v57, v19
    v_and_b32 v48, v58, v16
    v_and_b32 v49, v58, v17
    v_and_b32 v50, v58, v18
    v_and_b32 v51, v58, v19
    v_and_b32 v52, v59, v16
    v_and_b32 v53, v59, v17
    v_and_b32 v54, v59, v18
    v_and_b32 v55, v59, v19
    v_add_f32 v36, v36, v37
    v_add_f32 v38, v38, v39
    v_add_f32 v34, v34, v36
    v_add_f32 v34, v34, v38
    s_waitcnt vmcnt(5)
    buffer_load_dwordx4 v[136:139], v3, s[12:15], s30 offen offset:0 nt
    v_mfma_f32_16x16x32_bf16 v[20:23], v[112:115], v[40:43], v[20:23]
    s_waitcnt vmcnt(5)
    buffer_load_dwordx4 v[140:143], v3, s[12:15], s30 offen offset:128 nt
    v_mfma_f32_16x16x32_bf16 v[24:27], v[116:119], v[40:43], v[24:27]
    s_waitcnt vmcnt(5)
    buffer_load_dwordx4 v[144:147], v3, s[12:15], s30 offen offset:256 nt
    v_mfma_f32_16x16x32_bf16 v[28:31], v[120:123], v[40:43], v[28:31]
    s_waitcnt vmcnt(5)
    buffer_load_dwordx4 v[148:151], v3, s[12:15], s30 offen offset:3072 nt
    v_mfma_f32_16x16x32_bf16 v[20:23], v[124:127], v[44:47], v[20:23]
    s_waitcnt vmcnt(5)
    buffer_load_dwordx4 v[152:155], v3, s[12:15], s30 offen offset:3200 nt
    v_mfma_f32_16x16x32_bf16 v[24:27], v[128:131], v[44:47], v[24:27]
    s_waitcnt vmcnt(5)
    buffer_load_dwordx4 v[156:159], v3, s[12:15], s30 offen offset:3328 nt
    v_mfma_f32_16x16x32_bf16 v[28:31], v[132:135], v[44:47], v[28:31]
    s_waitcnt vmcnt(5)
    buffer_load_dwordx4 v[64:67], v2, s[8:11], s31 offen offset:0 nt
    v_mfma_f32_16x16x32_bf16 v[20:23], v[136:139], v[48:51], v[20:23]
    s_waitcnt vmcnt(5)
    buffer_load_dwordx4 v[68:71], v2, s[8:11], s31 offen offset:128 nt
    v_mfma_f32_16x16x32_bf16 v[24:27], v[140:143], v[48:51], v[24:27]
    s_waitcnt vmcnt(5)
    buffer_load_dwordx4 v[72:75], v2, s[8:11], s31 offen offset:256 nt
    v_mfma_f32_16x16x32_bf16 v[28:31], v[144:147], v[48:51], v[28:31]
    s_waitcnt vmcnt(5)
    buffer_load_dwordx4 v[76:79], v2, s[8:11], s31 offen offset:3072 nt
    v_mfma_f32_16x16x32_bf16 v[20:23], v[148:151], v[52:55], v[20:23]
    s_waitcnt vmcnt(5)
    buffer_load_dwordx4 v[80:83], v2, s[8:11], s31 offen offset:3200 nt
    v_mfma_f32_16x16x32_bf16 v[24:27], v[152:155], v[52:55], v[24:27]
    s_waitcnt vmcnt(5)
    buffer_load_dwordx4 v[84:87], v2, s[8:11], s31 offen offset:3328 nt
    v_mfma_f32_16x16x32_bf16 v[28:31], v[156:159], v[52:55], v[28:31]
    s_mov_b32 s30, s31
    s_add_u32 s39, s39, 1
    s_cmp_lt_u32 s39, 11
    s_nop 3
    s_cbranch_scc1 L_loop
    v_mov_b32 v35, 0
    s_mul_i32 s31, s5, 12288
    s_add_u32 s31, s31, s37
    s_add_u32 s43, s31, 98304
    s_waitcnt vmcnt(5)
    buffer_load_dwordx4 v[88:91], v3, s[8:11], s30 offen offset:0 nt
    v_dot2_f32_bf16 v40, v64, v4, 0
    v_dot2_f32_bf16 v41, v65, v5, 0
    v_dot2_f32_bf16 v40, v66, v6, v40
    v_dot2_f32_bf16 v41, v67, v7, v41
    s_waitcnt vmcnt(5)
    buffer_load_dwordx4 v[92:95], v3, s[8:11], s30 offen offset:128 nt
    v_dot2_f32_bf16 v40, v68, v8, v40
    v_dot2_f32_bf16 v41, v69, v9, v41
    v_dot2_f32_bf16 v40, v70, v10, v40
    v_dot2_f32_bf16 v41, v71, v11, v41
    s_waitcnt vmcnt(5)
    buffer_load_dwordx4 v[96:99], v3, s[8:11], s30 offen offset:256 nt
    v_dot2_f32_bf16 v40, v72, v12, v40
    v_dot2_f32_bf16 v41, v73, v13, v41
    v_dot2_f32_bf16 v40, v74, v14, v40
    v_dot2_f32_bf16 v41, v75, v15, v41
    s_waitcnt vmcnt(5)
    buffer_load_dwordx4 v[100:103], v3, s[8:11], s30 offen offset:3072 nt
    v_dot2_f32_bf16 v42, v76, v4, 0
    v_dot2_f32_bf16 v43, v77, v5, 0
    v_dot2_f32_bf16 v42, v78, v6, v42
    v_dot2_f32_bf16 v43, v79, v7, v43
    s_waitcnt vmcnt(5)
    buffer_load_dwordx4 v[104:107], v3, s[8:11], s30 offen offset:3200 nt
    v_dot2_f32_bf16 v42, v80, v8, v42
    v_dot2_f32_bf16 v43, v81, v9, v43
    v_dot2_f32_bf16 v42, v82, v10, v42
    v_dot2_f32_bf16 v43, v83, v11, v43
    s_waitcnt vmcnt(5)
    buffer_load_dwordx4 v[108:111], v3, s[8:11], s30 offen offset:3328 nt
    v_dot2_f32_bf16 v42, v84, v12, v42
    v_dot2_f32_bf16 v43, v85, v13, v43
    v_dot2_f32_bf16 v42, v86, v14, v42
    v_dot2_f32_bf16 v43, v87, v15, v43
    s_waitcnt vmcnt(5)
    buffer_load_dwordx4 v[112:115], v2, s[12:15], s30 offen offset:0 nt
    v_dot2_f32_bf16 v44, v88, v4, 0
    v_dot2_f32_bf16 v45, v89, v5, 0
    v_dot2_f32_bf16 v44, v90, v6, v44
    v_dot2_f32_bf16 v45, v91, v7, v45
    s_waitcnt vmcnt(5)
    buffer_load_dwordx4 v[116:119], v2, s[12:15], s30 offen offset:128 nt
    v_dot2_f32_bf16 v44, v92, v8, v44
    v_dot2_f32_bf16 v45, v93, v9, v45
    v_dot2_f32_bf16 v44, v94, v10, v44
    v_dot2_f32_bf16 v45, v95, v11, v45
    s_waitcnt vmcnt(5)
    buffer_load_dwordx4 v[120:123], v2, s[12:15], s30 offen offset:256 nt
    v_dot2_f32_bf16 v44, v96, v12, v44
    v_dot2_f32_bf16 v45, v97, v13, v45
    v_dot2_f32_bf16 v44, v98, v14, v44
    v_dot2_f32_bf16 v45, v99, v15, v45
    s_waitcnt vmcnt(5)
    buffer_load_dwordx4 v[124:127], v2, s[12:15], s30 offen offset:3072 nt
    v_dot2_f32_bf16 v46, v100, v4, 0
    v_dot2_f32_bf16 v47, v101, v5, 0
    v_dot2_f32_bf16 v46, v102, v6, v46
    v_dot2_f32_bf16 v47, v103, v7, v47
    s_waitcnt vmcnt(5)
    buffer_load_dwordx4 v[128:131], v2, s[12:15], s30 offen offset:3200 nt
    v_dot2_f32_bf16 v46, v104, v8, v46
    v_dot2_f32_bf16 v47, v105, v9, v47
    v_dot2_f32_bf16 v46, v106, v10, v46
    v_dot2_f32_bf16 v47, v107, v11, v47
    s_waitcnt vmcnt(5)
    buffer_load_dwordx4 v[132:135], v2, s[12:15], s30 offen offset:3328 nt
    v_dot2_f32_bf16 v46, v108, v12, v46
    v_dot2_f32_bf16 v47, v109, v13, v47
    v_dot2_f32_bf16 v46, v110, v14, v46
    v_dot2_f32_bf16 v47, v111, v15, v47
    v_add_f32 v36, v40, v41
    v_add_f32 v37, v42, v43
    v_add_f32 v38, v44, v45
    v_add_f32 v39, v46, v47
    v_add_f32_dpp v36, v36, v36 quad_perm:[1,0,3,2] row_mask:0xf bank_mask:0xf
    v_add_f32_dpp v37, v37, v37 quad_perm:[1,0,3,2] row_mask:0xf bank_mask:0xf
    v_add_f32_dpp v38, v38, v38 quad_perm:[1,0,3,2] row_mask:0xf bank_mask:0xf
    v_add_f32_dpp v39, v39, v39 quad_perm:[1,0,3,2] row_mask:0xf bank_mask:0xf
    v_add_f32_dpp v36, v36, v36 quad_perm:[2,3,0,1] row_mask:0xf bank_mask:0xf
    v_add_f32_dpp v37, v37, v37 quad_perm:[2,3,0,1] row_mask:0xf bank_mask:0xf
    v_add_f32_dpp v38, v38, v38 quad_perm:[2,3,0,1] row_mask:0xf bank_mask:0xf
    v_add_f32_dpp v39, v39, v39 quad_perm:[2,3,0,1] row_mask:0xf bank_mask:0xf
    v_add_f32_dpp v36, v36, v36 row_half_mirror row_mask:0xf bank_mask:0xf
    v_add_f32_dpp v37, v37, v37 row_half_mirror row_mask:0xf bank_mask:0xf
    v_add_f32_dpp v38, v38, v38 row_half_mirror row_mask:0xf bank_mask:0xf
    v_add_f32_dpp v39, v39, v39 row_half_mirror row_mask:0xf bank_mask:0xf
    v_cvt_pk_bf16_f32 v56, v36, v37
    v_cvt_pk_bf16_f32 v57, v38, v39
    v_lshlrev_b32 v36, 16, v56
    v_and_b32 v37, 0xffff0000, v56
    v_lshlrev_b32 v38, 16, v57
    v_and_b32 v39, 0xffff0000, v57
    v_mul_f32 v36, s34, v36
    v_mul_f32 v37, s34, v37
    v_mul_f32 v38, s34, v38
    v_mul_f32 v39, s34, v39
    v_cvt_pk_bf16_f32 v56, v36, v37
    v_cvt_pk_bf16_f32 v57, v38, v39
    v_lshlrev_b32 v36, 16, v56
    v_and_b32 v37, 0xffff0000, v56
    v_lshlrev_b32 v38, 16, v57
    v_and_b32 v39, 0xffff0000, v57
    v_max3_f32 v56, v36, v37, v38
    v_max_f32 v56, v56, v39
    v_cmp_gt_f32 vcc, v56, v32
    s_nop 0
    s_cbranch_vccz L_nomax5
    v_max_f32 v32, v56, v32
    s_nop 1
    v_max_f32_dpp v32, v32, v32 row_ror:8 row_mask:0xf bank_mask:0xf
    v_mov_b32 v57, v32
    s_nop 1
    v_permlane16_swap_b32 v32, v57
    v_max_f32 v32, v32, v57
    v_mov_b32 v57, v32
    s_nop 1
    v_permlane32_swap_b32 v32, v57
    v_max_f32 v32, v32, v57
    v_mul_f32 v56, s35, v32
    v_ceil_f32 v56, v56
    v_sub_f32 v57, v33, v56
    v_exp_f32 v57, v57
    v_mov_b32 v33, v56
    v_mul_f32 v20, v20, v57
    v_mul_f32 v21, v21, v57
    v_mul_f32 v22, v22, v57
    v_mul_f32 v23, v23, v57
    v_mul_f32 v24, v24, v57
    v_mul_f32 v25, v25, v57
    v_mul_f32 v26, v26, v57
    v_mul_f32 v27, v27, v57
    v_mul_f32 v28, v28, v57
    v_mul_f32 v29, v29, v57
    v_mul_f32 v30, v30, v57
    v_mul_f32 v31, v31, v57
    v_mul_f32 v34, v34, v57
L_nomax5:
    v_fma_f32 v36, v36, s35, -v33
    v_fma_f32 v37, v37, s35, -v33
    v_fma_f32 v38, v38, s35, -v33
    v_fma_f32 v39, v39, s35, -v33
    v_exp_f32 v36, v36
    v_exp_f32 v37, v37
    v_exp_f32 v38, v38
    v_exp_f32 v39, v39
    v_cvt_pk_bf16_f32 v56, v36, v36
    v_cvt_pk_bf16_f32 v57, v37, v37
    v_cvt_pk_bf16_f32 v58, v38, v38
    v_cvt_pk_bf16_f32 v59, v39, v39
    v_and_b32 v40, v56, v16
    v_and_b32 v41, v56, v17
    v_and_b32 v42, v56, v18
    v_and_b32 v43, v56, v19
    v_and_b32 v44, v57, v16
    v_and_b32 v45, v57, v17
    v_and_b32 v46, v57, v18
    v_and_b32 v47, v57, v19
    v_and_b32 v48, v58, v16
    v_and_b32 v49, v58, v17
    v_and_b32 v50, v58, v18
    v_and_b32 v51, v58, v19
    v_and_b32 v52, v59, v16
    v_and_b32 v53, v59, v17
    v_and_b32 v54, v59, v18
    v_and_b32 v55, v59, v19
    v_add_f32 v36, v36, v37
    v_add_f32 v38, v38, v39
    v_add_f32 v34, v34, v36
    v_add_f32 v34, v34, v38
    s_waitcnt vmcnt(5)
    v_mov_b32 v56, 0
    s_mov_b64 exec, 1
    ds_max_i32 v35, v56 offset:0
    s_mov_b64 exec, -1
L_np1:
    buffer_load_dwordx4 v[136:139], v3, s[12:15], s30 offen offset:0 nt
    v_mfma_f32_16x16x32_bf16 v[20:23], v[112:115], v[40:43], v[20:23]
    s_waitcnt vmcnt(5)
    buffer_load_dwordx4 v[140:143], v3, s[12:15], s30 offen offset:128 nt
    v_mfma_f32_16x16x32_bf16 v[24:27], v[116:119], v[40:43], v[24:27]
    s_waitcnt vmcnt(5)
    buffer_load_dwordx4 v[144:147], v3, s[12:15], s30 offen offset:256 nt
    v_mfma_f32_16x16x32_bf16 v[28:31], v[120:123], v[40:43], v[28:31]
    s_waitcnt vmcnt(5)
    buffer_load_dwordx4 v[148:151], v3, s[12:15], s30 offen offset:3072 nt
    v_mfma_f32_16x16x32_bf16 v[20:23], v[124:127], v[44:47], v[20:23]
    s_waitcnt vmcnt(5)
    buffer_load_dwordx4 v[152:155], v3, s[12:15], s30 offen offset:3200 nt
    v_mfma_f32_16x16x32_bf16 v[24:27], v[128:131], v[44:47], v[24:27]
    s_waitcnt vmcnt(5)
    buffer_load_dwordx4 v[156:159], v3, s[12:15], s30 offen offset:3328 nt
    v_mfma_f32_16x16x32_bf16 v[28:31], v[132:135], v[44:47], v[28:31]
    s_waitcnt vmcnt(5)
    buffer_load_dwordx4 v[160:163], v2, s[8:11], s31 offen offset:0 nt
    v_mfma_f32_16x16x32_bf16 v[20:23], v[136:139], v[48:51], v[20:23]
    s_waitcnt vmcnt(5)
    buffer_load_dwordx4 v[164:167], v2, s[8:11], s31 offen offset:128 nt
    v_mfma_f32_16x16x32_bf16 v[24:27], v[140:143], v[48:51], v[24:27]
    s_waitcnt vmcnt(5)
    buffer_load_dwordx4 v[168:171], v2, s[8:11], s31 offen offset:256 nt
    v_mfma_f32_16x16x32_bf16 v[28:31], v[144:147], v[48:51], v[28:31]
    s_waitcnt vmcnt(5)
    buffer_load_dwordx4 v[172:175], v2, s[12:15], s31 offen offset:0 nt
    v_mfma_f32_16x16x32_bf16 v[20:23], v[148:151], v[52:55], v[20:23]
    s_waitcnt vmcnt(5)
    buffer_load_dwordx4 v[176:179], v2, s[12:15], s31 offen offset:128 nt
    v_mfma_f32_16x16x32_bf16 v[24:27], v[152:155], v[52:55], v[24:27]
    s_waitcnt vmcnt(5)
    buffer_load_dwordx4 v[180:183], v2, s[12:15], s31 offen offset:256 nt
    v_mfma_f32_16x16x32_bf16 v[28:31], v[156:159], v[52:55], v[28:31]
    s_mov_b32 s39, 1
    s_mov_b32 s41, 0
L_dyn0:
    s_mov_b32 s40, 200000
L_dread0:
    s_lshl_b32 s38, s39, 2
    v_mov_b32 v56, s38
    ds_read_b32 v56, v56 offset:25600
    s_waitcnt lgkmcnt(0)
    v_readfirstlane_b32 s38, v56
    s_cmp_lt_u32 s38, 128
    s_nop 2
    s_cbranch_scc1 L_dgot0
    s_cmp_eq_u32 s38, -1
    s_cbranch_scc0 L_dref0
    s_sub_u32 s40, s40, 1
    s_cmp_lg_u32 s40, 0
    s_cbranch_scc1 L_dread0
L_dref0:
    s_add_u32 s39, s39, 2
    s_branch L_dlast0
L_dgot0:
    s_mul_i32 s31, s38, 12288
    s_add_u32 s31, s31, s37
    v_mov_b32 v56, s39
    s_mov_b64 exec, 1
    ds_max_i32 v35, v56 offset:0
    s_mov_b64 exec, -1
L_np2:
    s_add_u32 s39, s39, 1
    s_waitcnt vmcnt(5)
    v_dot2_f32_bf16 v40, v160, v4, 0
    v_dot2_f32_bf16 v41, v161, v5, 0
    v_dot2_f32_bf16 v40, v162, v6, v40
    v_dot2_f32_bf16 v41, v163, v7, v41
    buffer_load_dwordx4 v[160:163], v2, s[8:11], s31 offen offset:0 nt
    s_waitcnt vmcnt(5)
    v_dot2_f32_bf16 v40, v164, v8, v40
    v_dot2_f32_bf16 v41, v165, v9, v41
    v_dot2_f32_bf16 v40, v166, v10, v40
    v_dot2_f32_bf16 v41, v167, v11, v41
    buffer_load_dwordx4 v[164:167], v2, s[8:11], s31 offen offset:128 nt
    s_waitcnt vmcnt(5)
    v_dot2_f32_bf16 v40, v168, v12, v40
    v_dot2_f32_bf16 v41, v169, v13, v41
    v_dot2_f32_bf16 v40, v170, v14, v40
    v_dot2_f32_bf16 v41, v171, v15, v41
    buffer_load_dwordx4 v[168:171], v2, s[8:11], s31 offen offset:256 nt
    s_nop 1
    v_add_f32 v36, v40, v41
    s_nop 1
    v_add_f32_dpp v36, v36, v36 quad_perm:[1,0,3,2] row_mask:0xf bank_mask:0xf
    s_nop 1
    v_add_f32_dpp v36, v36, v36 quad_perm:[2,3,0,1] row_mask:0xf bank_mask:0xf
    s_nop 1
    v_add_f32_dpp v36, v36, v36 row_half_mirror row_mask:0xf bank_mask:0xf
    v_cvt_pk_bf16_f32 v36, v36, v36
    v_and_b32 v36, 0xffff0000, v36
    v_mul_f32 v36, s34, v36
    v_cvt_pk_bf16_f32 v36, v36, v36
    v_and_b32 v36, 0xffff0000, v36
    v_cmp_gt_f32 vcc, v36, v32
    s_nop 0
    s_cbranch_vccz L_nomax6
    v_max_f32 v32, v36, v32
    s_nop 1
    v_max_f32_dpp v32, v32, v32 row_ror:8 row_mask:0xf bank_mask:0xf
    v_mov_b32 v57, v32
    s_nop 1
    v_permlane16_swap_b32 v32, v57
    v_max_f32 v32, v32, v57
    v_mov_b32 v57, v32
    s_nop 1
    v_permlane32_swap_b32 v32, v57
    v_max_f32 v32, v32, v57
    v_mul_f32 v56, s35, v32
    v_ceil_f32 v56, v56
    v_sub_f32 v57, v33, v56
    v_exp_f32 v57, v57
    v_mov_b32 v33, v56
    v_mul_f32 v20, v20, v57
    v_mul_f32 v21, v21, v57
    v_mul_f32 v22, v22, v57
    v_mul_f32 v23, v23, v57
    v_mul_f32 v24, v24, v57
    v_mul_f32 v25, v25, v57
    v_mul_f32 v26, v26, v57
    v_mul_f32 v27, v27, v57
    v_mul_f32 v28, v28, v57
    v_mul_f32 v29, v29, v57
    v_mul_f32 v30, v30, v57
    v_mul_f32 v31, v31, v57
    v_mul_f32 v34, v34, v57
L_nomax6:
    v_fma_f32 v36, v36, s35, -v33
    v_exp_f32 v36, v36
    s_nop 0
    v_cvt_pk_bf16_f32 v56, v36, v36
    v_add_f32 v34, v34, v36
    v_and_b32 v44, v56, v16
    v_and_b32 v45, v56, v17
    v_and_b32 v46, v56, v18
    v_and_b32 v47, v56, v19
    s_waitcnt vmcnt(5)
    s_nop 0
    v_mfma_f32_16x16x32_bf16 v[20:23], v[172:175], v[44:47], v[20:23]
    buffer_load_dwordx4 v[172:175], v2, s[12:15], s31 offen offset:0 nt
    s_waitcnt vmcnt(5)
    v_mfma_f32_16x16x32_bf16 v[24:27], v[176:179], v[44:47], v[24:27]
    buffer_load_dwordx4 v[176:179], v2, s[12:15], s31 offen offset:128 nt
    s_waitcnt vmcnt(5)
    v_mfma_f32_16x16x32_bf16 v[28:31], v[180:183], v[44:47], v[28:31]
    buffer_load_dwordx4 v[180:183], v2, s[12:15], s31 offen offset:256 nt
    s_nop 5
    s_branch L_dyn0
L_dlast0:
    v_mov_b32 v56, 0x7fffffff
    s_mov_b64 exec, 1
    ds_max_i32 v35, v56 offset:0
    s_mov_b64 exec, -1
L_np3:
    s_waitcnt vmcnt(5)
    v_dot2_f32_bf16 v40, v160, v4, 0
    v_dot2_f32_bf16 v41, v161, v5, 0
    v_dot2_f32_bf16 v40, v162, v6, v40
    v_dot2_f32_bf16 v41, v163, v7, v41
    s_waitcnt vmcnt(4)
    v_dot2_f32_bf16 v40, v164, v8, v40
    v_dot2_f32_bf16 v41, v165, v9, v41
    v_dot2_f32_bf16 v40, v166, v10, v40
    v_dot2_f32_bf16 v41, v167, v11, v41
    s_waitcnt vmcnt(3)
    v_dot2_f32_bf16 v40, v168, v12, v40
    v_dot2_f32_bf16 v41, v169, v13, v41
    v_dot2_f32_bf16 v40, v170, v14, v40
    v_dot2_f32_bf16 v41, v171, v15, v41
    s_nop 2
    v_add_f32 v36, v40, v41
    s_nop 1
    v_add_f32_dpp v36, v36, v36 quad_perm:[1,0,3,2] row_mask:0xf bank_mask:0xf
    s_nop 1
    v_add_f32_dpp v36, v36, v36 quad_perm:[2,3,0,1] row_mask:0xf bank_mask:0xf
    s_nop 1
    v_add_f32_dpp v36, v36, v36 row_half_mirror row_mask:0xf bank_mask:0xf
    v_cvt_pk_bf16_f32 v36, v36, v36
    v_and_b32 v36, 0xffff0000, v36
    v_mul_f32 v36, s34, v36
    v_cvt_pk_bf16_f32 v36, v36, v36
    v_and_b32 v36, 0xffff0000, v36
    v_cmp_gt_f32 vcc, v36, v32
    s_nop 0
    s_cbranch_vccz L_nomax7
    v_max_f32 v32, v36, v32
    s_nop 1
    v_max_f32_dpp v32, v32, v32 row_ror:8 row_mask:0xf bank_mask:0xf
    v_mov_b32 v57, v32
    s_nop 1
    v_permlane16_swap_b32 v32, v57
    v_max_f32 v32, v32, v57
    v_mov_b32 v57, v32
    s_nop 1
    v_permlane32_swap_b32 v32, v57
    v_max_f32 v32, v32, v57
    v_mul_f32 v56, s35, v32
    v_ceil_f32 v56, v56
    v_sub_f32 v57, v33, v56
    v_exp_f32 v57, v57
    v_mov_b32 v33, v56
    v_mul_f32 v20, v20, v57
    v_mul_f32 v21, v21, v57
    v_mul_f32 v22, v22, v57
    v_mul_f32 v23, v23, v57
    v_mul_f32 v24, v24, v57
    v_mul_f32 v25, v25, v57
    v_mul_f32 v26, v26, v57
    v_mul_f32 v27, v27, v57
    v_mul_f32 v28, v28, v57
    v_mul_f32 v29, v29, v57
    v_mul_f32 v30, v30, v57
    v_mul_f32 v31, v31, v57
    v_mul_f32 v34, v34, v57
L_nomax7:
    v_fma_f32 v36, v36, s35, -v33
    v_exp_f32 v36, v36
    s_nop 0
    v_cvt_pk_bf16_f32 v56, v36, v36
    v_add_f32 v34, v34, v36
    v_and_b32 v44, v56, v16
    v_and_b32 v45, v56, v17
    v_and_b32 v46, v56, v18
    v_and_b32 v47, v56, v19
    v_add_f32_dpp v34, v34, v34 row_ror:8 row_mask:0xf bank_mask:0xf
    v_mov_b32 v56, v34
    s_nop 1
    v_permlane16_swap_b32 v34, v56
    v_add_f32 v34, v34, v56
    v_mov_b32 v56, v34
    s_nop 1
    v_permlane32_swap_b32 v34, v56
    v_add_f32 v34, v34, v56
    v_mov_b32 v56, v33
    v_mov_b32 v57, v34
    s_lshl_b32 s38, s3, 3
    v_mov_b32 v58, s38
    s_mov_b64 exec, 1
    ds_write_b64 v58, v[56:57] offset:928
    s_mov_b64 exec, -1
    v_lshrrev_b32 v59, 5, v1
    v_mul_u32_u24 v59, 768, v59
    v_bfe_u32 v60, v1, 4, 1
    v_lshl_add_u32 v59, v60, 7, v59
    v_and_b32 v60, 7, v1
    v_lshl_add_u32 v59, v60, 4, v59
    s_mul_i32 s38, s3, 1536
    v_add_u32 v59, s38, v59
    v_lshrrev_b32 v35, 4, v1
    v_mul_u32_u24 v35, 192, v35
    v_and_b32 v60, 15, v1
    v_min_u32 v60, 11, v60
    v_lshl_add_u32 v35, v60, 4, v35
    v_add_u32 v35, 6144, v35
    v_mov_b32 v60, 32
    s_lshl_b32 s38, s2, 1
    s_add_u32 s38, s38, 1
    s_lshl_b32 s38, s38, 10
    s_add_u32 s38, s38, 1048576
    v_lshl_add_u32 v61, v1, 4, s38
    s_waitcnt vmcnt(2)
    v_mfma_f32_16x16x32_bf16 v[20:23], v[172:175], v[44:47], v[20:23]
    s_waitcnt vmcnt(1)
    v_mfma_f32_16x16x32_bf16 v[24:27], v[176:179], v[44:47], v[24:27]
    s_waitcnt vmcnt(0)
    v_mfma_f32_16x16x32_bf16 v[28:31], v[180:183], v[44:47], v[28:31]
L_dend:
    s_mov_b32 exec_lo, 0x00ff00ff
    s_mov_b32 exec_hi, 0xff00ff00
    s_nop 1
    ds_write_b128 v59, v[20:23] offset:14336
    s_nop 0
    ds_write_b128 v59, v[24:27] offset:14592
    s_nop 0
    ds_write_b128 v59, v[28:31] offset:14848
    s_mov_b64 exec, -1
    s_waitcnt lgkmcnt(0)
    s_barrier
    s_cmp_ge_u32 s3, 1
    s_cbranch_scc1 L_exit
    ds_read_b128 v[192:195], v60 offset:896
    ds_read_b128 v[196:199], v60 offset:912
    ds_read_b128 v[160:163], v35 offset:8192
    ds_read_b128 v[164:167], v35 offset:8960
    ds_read_b128 v[168:171], v35 offset:9728
    ds_read_b128 v[172:175], v35 offset:10496
    ds_read_b128 v[176:179], v35 offset:11264
    ds_read_b128 v[180:183], v35 offset:12032
    ds_read_b128 v[184:187], v35 offset:12800
    ds_read_b128 v[188:191], v35 offset:13568
    v_mov_b32 v202, 0xffffff00
    s_waitcnt lgkmcnt(8)
    v_max3_f32 v200, v192, v194, v196
    v_max_f32 v200, v200, v198
    v_sub_f32 v192, v192, v200
    v_sub_f32 v194, v194, v200
    v_sub_f32 v196, v196, v200
    v_sub_f32 v198, v198, v200
    v_exp_f32 v192, v192
    v_exp_f32 v194, v194
    v_exp_f32 v196, v196
    v_exp_f32 v198, v198
    v_mul_f32 v201, v192, v193
    v_fma_f32 v201, v194, v195, v201
    v_fma_f32 v201, v196, v197, v201
    v_fma_f32 v201, v198, v199, v201
    v_lshlrev_b32 v203, 8, v200
    v_lshlrev_b32 v204, 8, v201
    s_waitcnt lgkmcnt(0)
    v_add_f32 v160, v160, v164
    v_add_f32 v161, v161, v165
    v_add_f32 v162, v162, v166
    v_add_f32 v163, v163, v167
    v_add_f32 v168, v168, v172
    v_add_f32 v169, v169, v173
    v_add_f32 v170, v170, v174
    v_add_f32 v171, v171, v175
    v_add_f32 v176, v176, v180
    v_add_f32 v177, v177, v181
    v_add_f32 v178, v178, v182
    v_add_f32 v179, v179, v183
    v_add_f32 v184, v184, v188
    v_add_f32 v185, v185, v189
    v_add_f32 v186, v186, v190
    v_add_f32 v187, v187, v191
    v_mul_f32 v160, v160, v192
    v_mul_f32 v161, v161, v192
    v_mul_f32 v162, v162, v192
    v_mul_f32 v163, v163, v192
    v_fma_f32 v160, v168, v194, v160
    v_fma_f32 v161, v169, v194, v161
    v_fma_f32 v162, v170, v194, v162
    v_fma_f32 v163, v171, v194, v163
    v_fma_f32 v160, v176, v196, v160
    v_fma_f32 v161, v177, v196, v161
    v_fma_f32 v162, v178, v196, v162
    v_fma_f32 v163, v179, v196, v163
    v_fma_f32 v160, v184, v198, v160
    v_fma_f32 v161, v185, v198, v161
    v_fma_f32 v162, v186, v198, v162
    v_fma_f32 v163, v187, v198, v163
    s_mov_b32 exec_lo, 0x10001000
    s_mov_b32 exec_hi, 0x10001000
    v_mov_b32 v160, v200
    v_mov_b32 v161, v201
    v_mov_b32 v162, v203
    v_mov_b32 v163, v204
    s_mov_b64 exec, -1
    v_and_or_b32 v160, v160, v202, s20
    v_and_or_b32 v161, v161, v202, s21
    v_and_or_b32 v162, v162, v202, s22
    v_and_or_b32 v163, v163, v202, s23
    global_store_dwordx4 v61, v[160:163], s[88:89] sc1
    s_nop 0
    s_branch L_exit
.p2align 8
L_helper:
    v_and_b32 v1, 63, v0
    s_and_b32 s5, s2, 7
    s_sub_u32 s29, s3, 4
    v_lshlrev_b32 v2, 2, v1
    s_add_u32 s49, s4, s5
    s_lshr_b32 s38, s4, 3
    s_add_u32 s49, s49, s38
    s_and_b32 s49, s49, 7
    s_bfm_b32 s58, s4, 0
    s_and_b32 s59, s58, 0xf5f5f5f5
    s_bcnt1_i32_b32 s59, s59
    s_add_u32 s59, s59, 2
    s_sub_u32 s38, s59, 24
    s_cselect_b32 s59, s59, s38
    s_mul_i32 s34, s4, 3
    s_add_u32 s34, s34, s49
    s_add_u32 s35, s59, 96
    s_mov_b32 s46, 3072
    s_cmp_lt_u32 s49, 3
    s_cselect_b32 s33, s34, s59
    s_cselect_b32 s34, s34, s35
    s_cselect_b32 s35, 12288, s46
    s_mul_i32 s18, s35, 640
    s_mov_b32 s19, 0x20000
    s_mul_i32 s36, s29, 160
    s_mul_i32 s37, s36, s35
    s_lshl_b32 s38, s33, 7
    s_add_u32 s37, s37, s38
    s_mul_i32 s38, s35, 20
    v_lshrrev_b32 v3, 3, v1
    v_mul_lo_u32 v3, v3, s38
    v_and_b32 v4, 7, v1
    v_lshl_add_u32 v5, v4, 4, v3
    s_mov_b32 s45, 0xf5f5f5f5
    s_bitcmp1_b32 s45, s4
    s_cselect_b32 s45, 4, 3
    s_waitcnt lgkmcnt(0)
    s_cmp_lt_u32 s49, 3
    s_cselect_b32 s16, s70, s76
    s_cselect_b32 s17, s71, s77
    s_cmp_lt_u32 s49, s45
    s_cselect_b32 s45, 1, 0
    s_cbranch_scc1 L_hprod1
    s_branch L_hskip1
L_hprod1:
    global_load_dword v8, v2, s[64:65] offset:0
    global_load_dword v9, v2, s[64:65] offset:256
    global_load_dword v10, v2, s[64:65] offset:512
    global_load_dword v11, v2, s[64:65] offset:768
    global_load_dword v12, v2, s[64:65] offset:1024
    global_load_dword v13, v2, s[64:65] offset:1280
    global_load_dword v14, v2, s[64:65] offset:1536
    global_load_dword v15, v2, s[64:65] offset:1792
    global_load_dword v16, v2, s[64:65] offset:2048
    global_load_dword v17, v2, s[64:65] offset:2304
    buffer_load_dwordx4 v[64:67], v5, s[16:19], s37 offen nt
    s_add_u32 s37, s37, s35
    buffer_load_dwordx4 v[68:71], v5, s[16:19], s37 offen nt
    s_add_u32 s37, s37, s35
    buffer_load_dwordx4 v[72:75], v5, s[16:19], s37 offen nt
    s_add_u32 s37, s37, s35
    buffer_load_dwordx4 v[76:79], v5, s[16:19], s37 offen nt
    s_add_u32 s37, s37, s35
    buffer_load_dwordx4 v[80:83], v5, s[16:19], s37 offen nt
    s_add_u32 s37, s37, s35
    buffer_load_dwordx4 v[84:87], v5, s[16:19], s37 offen nt
    s_add_u32 s37, s37, s35
    buffer_load_dwordx4 v[88:91], v5, s[16:19], s37 offen nt
    s_add_u32 s37, s37, s35
    buffer_load_dwordx4 v[92:95], v5, s[16:19], s37 offen nt
    s_add_u32 s37, s37, s35
L_hskip1:
    s_mov_b32 s48, 3145728
    v_bfe_u32 v3, v1, 4, 1
    v_lshl_add_u32 v3, v3, 5, v4
    v_lshrrev_b32 v4, 5, v1
    v_lshl_add_u32 v3, v4, 4, v3
    v_bfe_u32 v4, v1, 3, 1
    s_lshl_b32 s38, s59, 7
    v_lshl_add_u32 v6, v3, 1, s38
    v_lshlrev_b32 v40, 3, v1
    v_add_u32 v40, s5, v40
    v_cmp_gt_u32 vcc, 1, v1
    s_nop 1
    v_cndmask_b32 v40, -1, v40, vcc
    v_mov_b32 v44, -1
    v_mov_b32 v45, -1
    v_mov_b32 v46, 0
    v_mov_b32 v47, 0
    ds_write_b32 v2, v40 offset:25600
    ds_write_b32 v2, v44 offset:25856
    ds_write_b32 v2, v44 offset:26112
    ds_write_b32 v2, v44 offset:26368
    ds_write_b128 v46, v[44:47] offset:0
    ds_write_b64 v46, v[46:47] offset:16
    s_load_dword s47, s[88:89], s48
    s_mov_b32 s27, 0x350000a0
    s_cmp_eq_u32 s49, 1
    s_cselect_b32 s27, 0xb53595b1, s27
    s_cselect_b32 s28, 17, 34
    s_cmp_eq_u32 s49, 0
    s_cselect_b32 s27, 0xb53595b1, s27
    s_cselect_b32 s28, 0, s28
    s_and_b32 s26, s27, s58
    s_bcnt1_i32_b32 s26, s26
    s_add_u32 s26, s26, s28
    s_bitcmp1_b32 s27, s4
    s_cselect_b32 s6, 1, 3
    s_mul_i32 s25, s26, 13108
    s_lshr_b32 s25, s25, 16
    s_mul_i32 s24, s25, 5
    s_sub_u32 s24, s26, s24
    s_add_u32 s27, s25, 32
    s_mov_b32 s28, 0x24a4a4a
    s_and_b32 s26, s28, s58
    s_bcnt1_i32_b32 s26, s26
    s_bitcmp1_b32 s28, s4
    s_cselect_b32 s28, 2, s6
    s_cmp_eq_u32 s49, 2
    s_cselect_b32 s6, s28, s6
    s_sub_u32 s28, s49, 3
    s_cmp_ge_u32 s49, 3
    s_cselect_b32 s6, 0, s6
    s_cselect_b32 s24, s28, s24
    s_cselect_b32 s27, s4, s27
    s_mul_i32 s7, s24, 40
    s_add_u32 s7, s7, s27
    s_lshl_b32 s7, s7, 10
    s_add_u32 s7, s7, 2097152
    v_and_b32 v46, 1, v1
    v_lshlrev_b32 v46, 4, v46
    v_mov_b32 v47, 0xffff
    v_lshlrev_b32 v46, v46, v47
    v_bfe_u32 v47, v1, 1, 2
    v_cmp_eq_u32 vcc, 0, v47
    s_nop 1
    v_cndmask_b32 v24, 0, v46, vcc
    v_cmp_eq_u32 vcc, 1, v47
    s_nop 1
    v_cndmask_b32 v25, 0, v46, vcc
    v_cmp_eq_u32 vcc, 2, v47
    s_nop 1
    v_cndmask_b32 v26, 0, v46, vcc
    v_cmp_eq_u32 vcc, 3, v47
    s_nop 1
    v_cndmask_b32 v27, 0, v46, vcc
    s_cmp_lg_u32 s45, 0
    s_cbranch_scc1 L_prod
    s_mov_b32 s16, s72
    s_mov_b32 s17, s73
    s_mov_b32 s18, 7864320
    s_mul_i32 s36, s4, 245760
    s_lshl_b32 s37, s24, 8
    s_add_u32 s36, s36, s37
    v_lshrrev_b32 v7, 4, v1
    v_mul_u32_u24 v7, 10240, v7
    v_and_b32 v8, 15, v1
    v_lshl_add_u32 v7, v8, 4, v7
    s_mul_i32 s37, s29, 12
    s_add_u32 s38, s37, 0
    s_lshr_b32 s39, s38, 3
    s_lshl_b32 s39, s39, 5
    s_and_b32 s38, s38, 7
    s_add_u32 s38, s38, s39
    s_mul_i32 s38, s38, 1280
    s_add_u32 s38, s38, s36
    buffer_load_dwordx4 v[160:163], v7, s[16:19], s38 offen nt
    s_add_u32 s38, s37, 1
    s_lshr_b32 s39, s38, 3
    s_lshl_b32 s39, s39, 5
    s_and_b32 s38, s38, 7
    s_add_u32 s38, s38, s39
    s_mul_i32 s38, s38, 1280
    s_add_u32 s38, s38, s36
    buffer_load_dwordx4 v[164:167], v7, s[16:19], s38 offen nt
    s_add_u32 s38, s37, 2
    s_lshr_b32 s39, s38, 3
    s_lshl_b32 s39, s39, 5
    s_and_b32 s38, s38, 7
    s_add_u32 s38, s38, s39
    s_mul_i32 s38, s38, 1280
    s_add_u32 s38, s38, s36
    buffer_load_dwordx4 v[168:171], v7, s[16:19], s38 offen nt
    s_add_u32 s38, s37, 3
    s_lshr_b32 s39, s38, 3
    s_lshl_b32 s39, s39, 5
    s_and_b32 s38, s38, 7
    s_add_u32 s38, s38, s39
    s_mul_i32 s38, s38, 1280
    s_add_u32 s38, s38, s36
    buffer_load_dwordx4 v[172:175], v7, s[16:19], s38 offen nt
    s_add_u32 s38, s37, 4
    s_lshr_b32 s39, s38, 3
    s_lshl_b32 s39, s39, 5
    s_and_b32 s38, s38, 7
    s_add_u32 s38, s38, s39
    s_mul_i32 s38, s38, 1280
    s_add_u32 s38, s38, s36
    buffer_load_dwordx4 v[176:179], v7, s[16:19], s38 offen nt
    s_add_u32 s38, s37, 5
    s_lshr_b32 s39, s38, 3
    s_lshl_b32 s39, s39, 5
    s_and_b32 s38, s38, 7
    s_add_u32 s38, s38, s39
    s_mul_i32 s38, s38, 1280
    s_add_u32 s38, s38, s36
    buffer_load_dwordx4 v[180:183], v7, s[16:19], s38 offen nt
    s_add_u32 s38, s37, 6
    s_lshr_b32 s39, s38, 3
    s_lshl_b32 s39, s39, 5
    s_and_b32 s38, s38, 7
    s_add_u32 s38, s38, s39
    s_mul_i32 s38, s38, 1280
    s_add_u32 s38, s38, s36
    buffer_load_dwordx4 v[184:187], v7, s[16:19], s38 offen nt
    s_waitcnt lgkmcnt(0)
    s_and_b32 s20, s47, 0x7f7f7f7f
    s_add_u32 s20, s20, 0x6b2f593d
    s_xor_b32 s47, s47, 0x6b2f593d
    s_and_b32 s47, s47, 0x80808080
    s_xor_b32 s47, s47, s20
    s_and_b32 s20, s47, 0xff
    s_bfe_u32 s21, s47, 0x80008
    s_bfe_u32 s22, s47, 0x80010
    s_lshr_b32 s23, s47, 24
    s_cmp_lg_u32 s49, 7
    s_cbranch_scc1 L_qpoll
    s_cmp_lg_u32 s29, 3
    s_cbranch_scc1 L_qpoll
    s_mul_i32 s38, s4, 4352
    s_add_u32 s38, s38, 3149824
    v_mov_b32 v45, s38
    v_mov_b32 v46, 0
    v_mov_b32 v47, s47
    s_mov_b64 exec, 1
    global_store_dwordx2 v45, v[46:47], s[88:89] sc1
    s_mov_b64 exec, -1
    s_branch L_qpoll
L_prod:
    s_waitcnt vmcnt(8)
    v_lshlrev_b32 v184, 16, v8
    v_and_b32 v185, 0xffff0000, v8
    v_lshlrev_b32 v186, 16, v9
    v_and_b32 v187, 0xffff0000, v9
    v_lshlrev_b32 v188, 16, v10
    v_and_b32 v189, 0xffff0000, v10
    v_lshlrev_b32 v190, 16, v11
    v_and_b32 v191, 0xffff0000, v11
    v_lshlrev_b32 v192, 16, v12
    v_and_b32 v193, 0xffff0000, v12
    v_lshlrev_b32 v194, 16, v13
    v_and_b32 v195, 0xffff0000, v13
    v_lshlrev_b32 v196, 16, v14
    v_and_b32 v197, 0xffff0000, v14
    v_lshlrev_b32 v198, 16, v15
    v_and_b32 v199, 0xffff0000, v15
    v_lshlrev_b32 v200, 16, v16
    v_and_b32 v201, 0xffff0000, v16
    buffer_load_dwordx4 v[96:99], v5, s[16:19], s37 offen nt
    s_add_u32 s37, s37, s35
    v_lshlrev_b32 v202, 16, v17
    v_and_b32 v203, 0xffff0000, v17
    v_add_f32 v48, v184, v185
    v_add_f32 v49, v194, v195
    v_add_f32 v48, v48, v186
    v_add_f32 v49, v49, v196
    v_add_f32 v48, v48, v187
    v_add_f32 v49, v49, v197
    v_add_f32 v48, v48, v188
    v_add_f32 v49, v49, v198
    v_add_f32 v48, v48, v189
    v_add_f32 v49, v49, v199
    v_add_f32 v48, v48, v190
    v_add_f32 v49, v49, v200
    v_add_f32 v48, v48, v191
    v_add_f32 v49, v49, v201
    v_add_f32 v48, v48, v192
    v_add_f32 v49, v49, v202
    buffer_load_dwordx4 v[100:103], v5, s[16:19], s37 offen nt
    s_add_u32 s37, s37, s35
    v_add_f32 v48, v48, v193
    v_add_f32 v49, v49, v203
    s_nop 0
    v_add_f32_dpp v48, v48, v48 quad_perm:[1,0,3,2] row_mask:0xf bank_mask:0xf
    v_add_f32_dpp v49, v49, v49 quad_perm:[1,0,3,2] row_mask:0xf bank_mask:0xf
    s_nop 0
    v_add_f32_dpp v48, v48, v48 quad_perm:[2,3,0,1] row_mask:0xf bank_mask:0xf
    v_add_f32_dpp v49, v49, v49 quad_perm:[2,3,0,1] row_mask:0xf bank_mask:0xf
    s_nop 0
    v_add_f32_dpp v48, v48, v48 row_half_mirror row_mask:0xf bank_mask:0xf
    v_add_f32_dpp v49, v49, v49 row_half_mirror row_mask:0xf bank_mask:0xf
    s_nop 0
    v_add_f32_dpp v48, v48, v48 row_ror:8 row_mask:0xf bank_mask:0xf
    v_add_f32_dpp v49, v49, v49 row_ror:8 row_mask:0xf bank_mask:0xf
    v_mov_b32 v50, v48
    v_mov_b32 v51, v49
    s_nop 0
    v_permlane16_swap_b32 v48, v50
    v_permlane16_swap_b32 v49, v51
    v_add_f32 v48, v48, v50
    v_add_f32 v49, v49, v51
    v_mov_b32 v50, v48
    v_mov_b32 v51, v49
    buffer_load_dwordx4 v[104:107], v5, s[16:19], s37 offen nt
    s_add_u32 s37, s37, s35
    v_permlane32_swap_b32 v48, v50
    v_permlane32_swap_b32 v49, v51
    v_add_f32 v48, v48, v50
    v_add_f32 v49, v49, v51
    s_mov_b32 s38, 0x3acccccd
    v_mul_f32 v48, s38, v48
    v_mul_f32 v49, s38, v49
    v_sub_f32 v50, v184, v48
    v_sub_f32 v51, v194, v49
    v_mul_f32 v52, v50, v50
    v_mul_f32 v53, v51, v51
    v_sub_f32 v50, v185, v48
    v_sub_f32 v51, v195, v49
    v_fma_f32 v52, v50, v50, v52
    v_fma_f32 v53, v51, v51, v53
    v_sub_f32 v50, v186, v48
    v_sub_f32 v51, v196, v49
    v_fma_f32 v52, v50, v50, v52
    buffer_load_dwordx4 v[108:111], v5, s[16:19], s37 offen nt
    s_add_u32 s37, s37, s35
    v_fma_f32 v53, v51, v51, v53
    v_sub_f32 v50, v187, v48
    v_sub_f32 v51, v197, v49
    v_fma_f32 v52, v50, v50, v52
    v_fma_f32 v53, v51, v51, v53
    v_sub_f32 v50, v188, v48
    v_sub_f32 v51, v198, v49
    v_fma_f32 v52, v50, v50, v52
    v_fma_f32 v53, v51, v51, v53
    v_sub_f32 v50, v189, v48
    v_sub_f32 v51, v199, v49
    v_fma_f32 v52, v50, v50, v52
    v_fma_f32 v53, v51, v51, v53
    v_sub_f32 v50, v190, v48
    v_sub_f32 v51, v200, v49
    v_fma_f32 v52, v50, v50, v52
    v_fma_f32 v53, v51, v51, v53
    v_sub_f32 v50, v191, v48
    buffer_load_dwordx4 v[112:115], v5, s[16:19], s37 offen nt
    s_add_u32 s37, s37, s35
    v_sub_f32 v51, v201, v49
    v_fma_f32 v52, v50, v50, v52
    v_fma_f32 v53, v51, v51, v53
    v_sub_f32 v50, v192, v48
    v_sub_f32 v51, v202, v49
    v_fma_f32 v52, v50, v50, v52
    v_fma_f32 v53, v51, v51, v53
    v_sub_f32 v50, v193, v48
    v_sub_f32 v51, v203, v49
    v_fma_f32 v52, v50, v50, v52
    v_fma_f32 v53, v51, v51, v53
    s_nop 0
    v_add_f32_dpp v52, v52, v52 quad_perm:[1,0,3,2] row_mask:0xf bank_mask:0xf
    v_add_f32_dpp v53, v53, v53 quad_perm:[1,0,3,2] row_mask:0xf bank_mask:0xf
    s_nop 0
    v_add_f32_dpp v52, v52, v52 quad_perm:[2,3,0,1] row_mask:0xf bank_mask:0xf
    v_add_f32_dpp v53, v53, v53 quad_perm:[2,3,0,1] row_mask:0xf bank_mask:0xf
    s_nop 0
    v_add_f32_dpp v52, v52, v52 row_half_mirror row_mask:0xf bank_mask:0xf
    v_add_f32_dpp v53, v53, v53 row_half_mirror row_mask:0xf bank_mask:0xf
    s_nop 0
    v_add_f32_dpp v52, v52, v52 row_ror:8 row_mask:0xf bank_mask:0xf
    buffer_load_dwordx4 v[116:119], v5, s[16:19], s37 offen nt
    s_add_u32 s37, s37, s35
    v_add_f32_dpp v53, v53, v53 row_ror:8 row_mask:0xf bank_mask:0xf
    v_mov_b32 v50, v52
    v_mov_b32 v51, v53
    s_nop 0
    v_permlane16_swap_b32 v52, v50
    v_permlane16_swap_b32 v53, v51
    v_add_f32 v52, v52, v50
    v_add_f32 v53, v53, v51
    v_mov_b32 v50, v52
    v_mov_b32 v51, v53
    s_nop 0
    v_permlane32_swap_b32 v52, v50
    v_permlane32_swap_b32 v53, v51
    v_add_f32 v52, v52, v50
    v_add_f32 v53, v53, v51
    v_mul_f32 v52, s38, v52
    v_mul_f32 v53, s38, v53
    v_cvt_pk_bf16_f32 v48, v48, v48
    v_and_b32 v48, 0xffff0000, v48
    v_cvt_pk_bf16_f32 v49, v49, v49
    buffer_load_dwordx4 v[120:123], v5, s[16:19], s37 offen nt
    s_add_u32 s37, s37, s35
    v_and_b32 v49, 0xffff0000, v49
    v_cvt_pk_bf16_f32 v52, v52, v52
    v_and_b32 v52, 0xffff0000, v52
    v_cvt_pk_bf16_f32 v53, v53, v53
    v_and_b32 v53, 0xffff0000, v53
    v_add_f32 v52, 0x3727c5ac, v52
    v_add_f32 v53, 0x3727c5ac, v53
    v_cvt_pk_bf16_f32 v52, v52, v52
    v_and_b32 v52, 0xffff0000, v52
    v_cvt_pk_bf16_f32 v53, v53, v53
    v_and_b32 v53, 0xffff0000, v53
    v_sqrt_f32 v52, v52
    v_sqrt_f32 v53, v53
    v_cvt_pk_bf16_f32 v52, v52, v52
    v_and_b32 v52, 0xffff0000, v52
    v_cvt_pk_bf16_f32 v53, v53, v53
    v_and_b32 v53, 0xffff0000, v53
    v_rcp_f32 v50, v52
    buffer_load_dwordx4 v[124:127], v5, s[16:19], s37 offen nt
    s_add_u32 s37, s37, s35
    v_rcp_f32 v51, v53
    v_sub_f32 v184, v184, v48
    v_sub_f32 v185, v185, v48
    v_sub_f32 v186, v186, v48
    v_sub_f32 v187, v187, v48
    v_sub_f32 v188, v188, v48
    v_sub_f32 v189, v189, v48
    v_sub_f32 v190, v190, v48
    v_sub_f32 v191, v191, v48
    v_sub_f32 v192, v192, v48
    v_sub_f32 v193, v193, v48
    v_sub_f32 v194, v194, v49
    v_sub_f32 v195, v195, v49
    v_sub_f32 v196, v196, v49
    v_sub_f32 v197, v197, v49
    v_sub_f32 v198, v198, v49
    v_sub_f32 v199, v199, v49
    v_sub_f32 v200, v200, v49
    buffer_load_dwordx4 v[128:131], v5, s[16:19], s37 offen nt
    s_add_u32 s37, s37, s35
    v_sub_f32 v201, v201, v49
    v_sub_f32 v202, v202, v49
    v_sub_f32 v203, v203, v49
    v_cvt_pk_bf16_f32 v184, v184, v184
    v_and_b32 v184, 0xffff0000, v184
    v_cvt_pk_bf16_f32 v185, v185, v185
    v_and_b32 v185, 0xffff0000, v185
    v_cvt_pk_bf16_f32 v186, v186, v186
    v_and_b32 v186, 0xffff0000, v186
    v_cvt_pk_bf16_f32 v187, v187, v187
    v_and_b32 v187, 0xffff0000, v187
    v_cvt_pk_bf16_f32 v188, v188, v188
    v_and_b32 v188, 0xffff0000, v188
    v_cvt_pk_bf16_f32 v189, v189, v189
    v_and_b32 v189, 0xffff0000, v189
    v_cvt_pk_bf16_f32 v190, v190, v190
    v_and_b32 v190, 0xffff0000, v190
    v_cvt_pk_bf16_f32 v191, v191, v191
    buffer_load_dwordx4 v[132:135], v5, s[16:19], s37 offen nt
    s_add_u32 s37, s37, s35
    v_and_b32 v191, 0xffff0000, v191
    v_cvt_pk_bf16_f32 v192, v192, v192
    v_and_b32 v192, 0xffff0000, v192
    v_cvt_pk_bf16_f32 v193, v193, v193
    v_and_b32 v193, 0xffff0000, v193
    v_cvt_pk_bf16_f32 v194, v194, v194
    v_and_b32 v194, 0xffff0000, v194
    v_cvt_pk_bf16_f32 v195, v195, v195
    v_and_b32 v195, 0xffff0000, v195
    v_cvt_pk_bf16_f32 v196, v196, v196
    v_and_b32 v196, 0xffff0000, v196
    v_cvt_pk_bf16_f32 v197, v197, v197
    v_and_b32 v197, 0xffff0000, v197
    v_cvt_pk_bf16_f32 v198, v198, v198
    v_and_b32 v198, 0xffff0000, v198
    v_cvt_pk_bf16_f32 v199, v199, v199
    v_and_b32 v199, 0xffff0000, v199
    v_cvt_pk_bf16_f32 v200, v200, v200
    buffer_load_dwordx4 v[136:139], v5, s[16:19], s37 offen nt
    s_add_u32 s37, s37, s35
    v_and_b32 v200, 0xffff0000, v200
    v_cvt_pk_bf16_f32 v201, v201, v201
    v_and_b32 v201, 0xffff0000, v201
    v_cvt_pk_bf16_f32 v202, v202, v202
    v_and_b32 v202, 0xffff0000, v202
    v_cvt_pk_bf16_f32 v203, v203, v203
    v_and_b32 v203, 0xffff0000, v203
    v_mul_f32 v204, v184, v50
    v_mul_f32 v205, v185, v50
    v_mul_f32 v206, v186, v50
    v_mul_f32 v207, v187, v50
    v_mul_f32 v208, v188, v50
    v_mul_f32 v209, v189, v50
    v_mul_f32 v210, v190, v50
    v_mul_f32 v211, v191, v50
    v_mul_f32 v212, v192, v50
    v_mul_f32 v213, v193, v50
    v_mul_f32 v214, v194, v51
    buffer_load_dwordx4 v[140:143], v5, s[16:19], s37 offen nt
    global_load_ushort v18, v6, s[78:79]
    global_load_ushort v19, v6, s[78:79] offset:16
    s_waitcnt lgkmcnt(0)
    s_barrier
    v_mul_f32 v215, v195, v51
    v_mul_f32 v216, v196, v51
    v_mul_f32 v217, v197, v51
    v_mul_f32 v218, v198, v51
    v_mul_f32 v219, v199, v51
    v_mul_f32 v220, v200, v51
    v_mul_f32 v221, v201, v51
    v_mul_f32 v222, v202, v51
    v_mul_f32 v223, v203, v51
    v_fma_f32 v184, -v204, v52, v184
    v_fma_f32 v185, -v205, v52, v185
    v_fma_f32 v186, -v206, v52, v186
    v_fma_f32 v187, -v207, v52, v187
    v_fma_f32 v188, -v208, v52, v188
    v_fma_f32 v189, -v209, v52, v189
    v_fma_f32 v190, -v210, v52, v190
    v_fma_f32 v191, -v211, v52, v191
    v_fma_f32 v192, -v212, v52, v192
    v_fma_f32 v193, -v213, v52, v193
    v_fma_f32 v194, -v214, v53, v194
    v_fma_f32 v195, -v215, v53, v195
    v_fma_f32 v196, -v216, v53, v196
    v_fma_f32 v197, -v217, v53, v197
    v_fma_f32 v198, -v218, v53, v198
    v_fma_f32 v199, -v219, v53, v199
    v_fma_f32 v200, -v220, v53, v200
    v_fma_f32 v201, -v221, v53, v201
    v_fma_f32 v202, -v222, v53, v202
    v_fma_f32 v203, -v223, v53, v203
    v_fma_f32 v204, v184, v50, v204
    v_fma_f32 v205, v185, v50, v205
    v_fma_f32 v206, v186, v50, v206
    v_fma_f32 v207, v187, v50, v207
    v_fma_f32 v208, v188, v50, v208
    v_fma_f32 v209, v189, v50, v209
    v_fma_f32 v210, v190, v50, v210
    v_fma_f32 v211, v191, v50, v211
    v_fma_f32 v212, v192, v50, v212
    v_fma_f32 v213, v193, v50, v213
    v_fma_f32 v214, v194, v51, v214
    v_fma_f32 v215, v195, v51, v215
    v_fma_f32 v216, v196, v51, v216
    v_fma_f32 v217, v197, v51, v217
    v_fma_f32 v218, v198, v51, v218
    v_fma_f32 v219, v199, v51, v219
    v_fma_f32 v220, v200, v51, v220
    v_fma_f32 v221, v201, v51, v221
    v_fma_f32 v222, v202, v51, v222
    v_fma_f32 v223, v203, v51, v223
    v_cvt_pk_bf16_f32 v204, v204, v204
    v_cvt_pk_bf16_f32 v205, v205, v205
    v_cvt_pk_bf16_f32 v206, v206, v206
    v_cvt_pk_bf16_f32 v207, v207, v207
    v_cvt_pk_bf16_f32 v208, v208, v208
    v_cvt_pk_bf16_f32 v209, v209, v209
    v_cvt_pk_bf16_f32 v210, v210, v210
    v_cvt_pk_bf16_f32 v211, v211, v211
    v_cvt_pk_bf16_f32 v212, v212, v212
    v_cvt_pk_bf16_f32 v213, v213, v213
    v_cvt_pk_bf16_f32 v214, v214, v214
    v_cvt_pk_bf16_f32 v215, v215, v215
    v_cvt_pk_bf16_f32 v216, v216, v216
    v_cvt_pk_bf16_f32 v217, v217, v217
    v_cvt_pk_bf16_f32 v218, v218, v218
    v_cvt_pk_bf16_f32 v219, v219, v219
    v_cvt_pk_bf16_f32 v220, v220, v220
    v_cvt_pk_bf16_f32 v221, v221, v221
    v_cvt_pk_bf16_f32 v222, v222, v222
    v_cvt_pk_bf16_f32 v223, v223, v223
    v_lshlrev_b32 v48, 3, v1
    ds_write_b64 v48, v[204:205] offset:3072
    ds_write_b64 v48, v[206:207] offset:3584
    ds_write_b64 v48, v[208:209] offset:4096
    ds_write_b64 v48, v[210:211] offset:4608
    ds_write_b64 v48, v[212:213] offset:5120
    ds_write_b64 v48, v[214:215] offset:5632
    ds_write_b64 v48, v[216:217] offset:6144
    ds_write_b64 v48, v[218:219] offset:6656
    ds_write_b64 v48, v[220:221] offset:7168
    ds_write_b64 v48, v[222:223] offset:7680
    v_mul_u32_u24 v49, 2560, v4
    v_lshrrev_b32 v50, 4, v1
    v_mul_u32_u24 v50, 160, v50
    s_lshl_b32 s38, s36, 2
    v_add3_u32 v49, v49, v50, s38
    ds_read_b128 v[144:147], v49 offset:3072
    ds_read_b128 v[148:151], v49 offset:3088
    ds_read_b128 v[152:155], v49 offset:3104
    ds_read_b128 v[156:159], v49 offset:3120
    ds_read_b128 v[160:163], v49 offset:3136
    ds_read_b128 v[164:167], v49 offset:3152
    ds_read_b128 v[168:171], v49 offset:3168
    ds_read_b128 v[172:175], v49 offset:3184
    ds_read_b128 v[176:179], v49 offset:3200
    ds_read_b128 v[180:183], v49 offset:3216
    v_mov_b32 v28, 0
    v_mov_b32 v29, 0
    v_mov_b32 v30, 0
    v_mov_b32 v31, 0
    v_mov_b32 v32, 0
    v_mov_b32 v33, 0
    v_mov_b32 v34, 0
    v_mov_b32 v35, 0
    s_lshl_b32 s38, s29, 9
    v_add_u32 v50, s38, v48
    s_lshl_b32 s38, s34, 9
    v_add_u32 v51, s38, v48
    s_waitcnt lgkmcnt(0)
    s_and_b32 s20, s47, 0x7f7f7f7f
    s_add_u32 s20, s20, 0x6b2f593d
    s_xor_b32 s47, s47, 0x6b2f593d
    s_and_b32 s47, s47, 0x80808080
    s_xor_b32 s47, s47, s20
    s_and_b32 s20, s47, 0xff
    s_bfe_u32 s21, s47, 0x80008
    s_bfe_u32 s22, s47, 0x80010
    s_lshr_b32 s23, s47, 24
    v_and_b32 v224, v144, v24
    v_and_b32 v225, v144, v25
    v_and_b32 v226, v144, v26
    v_and_b32 v227, v144, v27
    v_and_b32 v228, v164, v24
    v_and_b32 v229, v164, v25
    v_and_b32 v230, v164, v26
    v_and_b32 v231, v164, v27
    v_and_b32 v232, v145, v24
    v_and_b32 v233, v145, v25
    v_and_b32 v234, v145, v26
    v_and_b32 v235, v145, v27
    v_and_b32 v236, v165, v24
    v_and_b32 v237, v165, v25
    v_and_b32 v238, v165, v26
    v_and_b32 v239, v165, v27
    s_waitcnt vmcnt(21)
    v_mfma_f32_16x16x32_bf16 v[28:31], v[64:67], v[224:227], v[28:31]
    v_mfma_f32_16x16x32_bf16 v[32:35], v[64:67], v[228:231], v[32:35]
    v_and_b32 v240, v146, v24
    v_and_b32 v241, v146, v25
    v_and_b32 v242, v146, v26
    v_and_b32 v243, v146, v27
    v_and_b32 v244, v166, v24
    v_and_b32 v245, v166, v25
    v_and_b32 v246, v166, v26
    v_and_b32 v247, v166, v27
    s_waitcnt vmcnt(20)
    v_mfma_f32_16x16x32_bf16 v[28:31], v[68:71], v[232:235], v[28:31]
    v_mfma_f32_16x16x32_bf16 v[32:35], v[68:71], v[236:239], v[32:35]
    v_and_b32 v248, v147, v24
    v_and_b32 v249, v147, v25
    v_and_b32 v250, v147, v26
    v_and_b32 v251, v147, v27
    v_and_b32 v252, v167, v24
    v_and_b32 v253, v167, v25
    v_and_b32 v254, v167, v26
    v_and_b32 v255, v167, v27
    s_waitcnt vmcnt(19)
    v_mfma_f32_16x16x32_bf16 v[28:31], v[72:75], v[240:243], v[28:31]
    v_mfma_f32_16x16x32_bf16 v[32:35], v[72:75], v[244:247], v[32:35]
    v_and_b32 v224, v148, v24
    v_and_b32 v225, v148, v25
    v_and_b32 v226, v148, v26
    v_and_b32 v227, v148, v27
    v_and_b32 v228, v168, v24
    v_and_b32 v229, v168, v25
    v_and_b32 v230, v168, v26
    v_and_b32 v231, v168, v27
    s_waitcnt vmcnt(18)
    v_mfma_f32_16x16x32_bf16 v[28:31], v[76:79], v[248:251], v[28:31]
    v_mfma_f32_16x16x32_bf16 v[32:35], v[76:79], v[252:255], v[32:35]
    v_and_b32 v232, v149, v24
    v_and_b32 v233, v149, v25
    v_and_b32 v234, v149, v26
    v_and_b32 v235, v149, v27
    v_and_b32 v236, v169, v24
    v_and_b32 v237, v169, v25
    v_and_b32 v238, v169, v26
    v_and_b32 v239, v169, v27
    s_waitcnt vmcnt(17)
    v_mfma_f32_16x16x32_bf16 v[28:31], v[80:83], v[224:227], v[28:31]
    v_mfma_f32_16x16x32_bf16 v[32:35], v[80:83], v[228:231], v[32:35]
    v_and_b32 v240, v150, v24
    v_and_b32 v241, v150, v25
    v_and_b32 v242, v150, v26
    v_and_b32 v243, v150, v27
    v_and_b32 v244, v170, v24
    v_and_b32 v245, v170, v25
    v_and_b32 v246, v170, v26
    v_and_b32 v247, v170, v27
    s_waitcnt vmcnt(16)
    v_mfma_f32_16x16x32_bf16 v[28:31], v[84:87], v[232:235], v[28:31]
    v_mfma_f32_16x16x32_bf16 v[32:35], v[84:87], v[236:239], v[32:35]
    v_and_b32 v248, v151, v24
    v_and_b32 v249, v151, v25
    v_and_b32 v250, v151, v26
    v_and_b32 v251, v151, v27
    v_and_b32 v252, v171, v24
    v_and_b32 v253, v171, v25
    v_and_b32 v254, v171, v26
    v_and_b32 v255, v171, v27
    s_waitcnt vmcnt(15)
    v_mfma_f32_16x16x32_bf16 v[28:31], v[88:91], v[240:243], v[28:31]
    v_mfma_f32_16x16x32_bf16 v[32:35], v[88:91], v[244:247], v[32:35]
    v_and_b32 v224, v152, v24
    v_and_b32 v225, v152, v25
    v_and_b32 v226, v152, v26
    v_and_b32 v227, v152, v27
    v_and_b32 v228, v172, v24
    v_and_b32 v229, v172, v25
    v_and_b32 v230, v172, v26
    v_and_b32 v231, v172, v27
    s_waitcnt vmcnt(14)
    v_mfma_f32_16x16x32_bf16 v[28:31], v[92:95], v[248:251], v[28:31]
    v_mfma_f32_16x16x32_bf16 v[32:35], v[92:95], v[252:255], v[32:35]
    v_and_b32 v232, v153, v24
    v_and_b32 v233, v153, v25
    v_and_b32 v234, v153, v26
    v_and_b32 v235, v153, v27
    v_and_b32 v236, v173, v24
    v_and_b32 v237, v173, v25
    v_and_b32 v238, v173, v26
    v_and_b32 v239, v173, v27
    s_waitcnt vmcnt(13)
    v_mfma_f32_16x16x32_bf16 v[28:31], v[96:99], v[224:227], v[28:31]
    v_mfma_f32_16x16x32_bf16 v[32:35], v[96:99], v[228:231], v[32:35]
    v_and_b32 v240, v154, v24
    v_and_b32 v241, v154, v25
    v_and_b32 v242, v154, v26
    v_and_b32 v243, v154, v27
    v_and_b32 v244, v174, v24
    v_and_b32 v245, v174, v25
    v_and_b32 v246, v174, v26
    v_and_b32 v247, v174, v27
    s_waitcnt vmcnt(12)
    v_mfma_f32_16x16x32_bf16 v[28:31], v[100:103], v[232:235], v[28:31]
    v_mfma_f32_16x16x32_bf16 v[32:35], v[100:103], v[236:239], v[32:35]
    v_and_b32 v248, v155, v24
    v_and_b32 v249, v155, v25
    v_and_b32 v250, v155, v26
    v_and_b32 v251, v155, v27
    v_and_b32 v252, v175, v24
    v_and_b32 v253, v175, v25
    v_and_b32 v254, v175, v26
    v_and_b32 v255, v175, v27
    s_waitcnt vmcnt(11)
    v_mfma_f32_16x16x32_bf16 v[28:31], v[104:107], v[240:243], v[28:31]
    v_mfma_f32_16x16x32_bf16 v[32:35], v[104:107], v[244:247], v[32:35]
    v_and_b32 v224, v156, v24
    v_and_b32 v225, v156, v25
    v_and_b32 v226, v156, v26
    v_and_b32 v227, v156, v27
    v_and_b32 v228, v176, v24
    v_and_b32 v229, v176, v25
    v_and_b32 v230, v176, v26
    v_and_b32 v231, v176, v27
    s_waitcnt vmcnt(10)
    v_mfma_f32_16x16x32_bf16 v[28:31], v[108:111], v[248:251], v[28:31]
    v_mfma_f32_16x16x32_bf16 v[32:35], v[108:111], v[252:255], v[32:35]
    v_and_b32 v232, v157, v24
    v_and_b32 v233, v157, v25
    v_and_b32 v234, v157, v26
    v_and_b32 v235, v157, v27
    v_and_b32 v236, v177, v24
    v_and_b32 v237, v177, v25
    v_and_b32 v238, v177, v26
    v_and_b32 v239, v177, v27
    s_waitcnt vmcnt(9)
    v_mfma_f32_16x16x32_bf16 v[28:31], v[112:115], v[224:227], v[28:31]
    v_mfma_f32_16x16x32_bf16 v[32:35], v[112:115], v[228:231], v[32:35]
    v_and_b32 v240, v158, v24
    v_and_b32 v241, v158, v25
    v_and_b32 v242, v158, v26
    v_and_b32 v243, v158, v27
    v_and_b32 v244, v178, v24
    v_and_b32 v245, v178, v25
    v_and_b32 v246, v178, v26
    v_and_b32 v247, v178, v27
    s_waitcnt vmcnt(8)
    v_mfma_f32_16x16x32_bf16 v[28:31], v[116:119], v[232:235], v[28:31]
    v_mfma_f32_16x16x32_bf16 v[32:35], v[116:119], v[236:239], v[32:35]
    v_and_b32 v248, v159, v24
    v_and_b32 v249, v159, v25
    v_and_b32 v250, v159, v26
    v_and_b32 v251, v159, v27
    v_and_b32 v252, v179, v24
    v_and_b32 v253, v179, v25
    v_and_b32 v254, v179, v26
    v_and_b32 v255, v179, v27
    s_waitcnt vmcnt(7)
    v_mfma_f32_16x16x32_bf16 v[28:31], v[120:123], v[240:243], v[28:31]
    v_mfma_f32_16x16x32_bf16 v[32:35], v[120:123], v[244:247], v[32:35]
    v_and_b32 v224, v160, v24
    v_and_b32 v225, v160, v25
    v_and_b32 v226, v160, v26
    v_and_b32 v227, v160, v27
    v_and_b32 v228, v180, v24
    v_and_b32 v229, v180, v25
    v_and_b32 v230, v180, v26
    v_and_b32 v231, v180, v27
    s_waitcnt vmcnt(6)
    v_mfma_f32_16x16x32_bf16 v[28:31], v[124:127], v[248:251], v[28:31]
    v_mfma_f32_16x16x32_bf16 v[32:35], v[124:127], v[252:255], v[32:35]
    v_and_b32 v232, v161, v24
    v_and_b32 v233, v161, v25
    v_and_b32 v234, v161, v26
    v_and_b32 v235, v161, v27
    v_and_b32 v236, v181, v24
    v_and_b32 v237, v181, v25
    v_and_b32 v238, v181, v26
    v_and_b32 v239, v181, v27
    s_waitcnt vmcnt(5)
    v_mfma_f32_16x16x32_bf16 v[28:31], v[128:131], v[224:227], v[28:31]
    v_mfma_f32_16x16x32_bf16 v[32:35], v[128:131], v[228:231], v[32:35]
    v_and_b32 v240, v162, v24
    v_and_b32 v241, v162, v25
    v_and_b32 v242, v162, v26
    v_and_b32 v243, v162, v27
    v_and_b32 v244, v182, v24
    v_and_b32 v245, v182, v25
    v_and_b32 v246, v182, v26
    v_and_b32 v247, v182, v27
    s_waitcnt vmcnt(4)
    v_mfma_f32_16x16x32_bf16 v[28:31], v[132:135], v[232:235], v[28:31]
    v_mfma_f32_16x16x32_bf16 v[32:35], v[132:135], v[236:239], v[32:35]
    v_and_b32 v248, v163, v24
    v_and_b32 v249, v163, v25
    v_and_b32 v250, v163, v26
    v_and_b32 v251, v163, v27
    v_and_b32 v252, v183, v24
    v_and_b32 v253, v183, v25
    v_and_b32 v254, v183, v26
    v_and_b32 v255, v183, v27
    s_waitcnt vmcnt(3)
    v_mfma_f32_16x16x32_bf16 v[28:31], v[136:139], v[240:243], v[28:31]
    v_mfma_f32_16x16x32_bf16 v[32:35], v[136:139], v[244:247], v[32:35]
    s_waitcnt vmcnt(2)
    v_mfma_f32_16x16x32_bf16 v[28:31], v[140:143], v[248:251], v[28:31]
    v_mfma_f32_16x16x32_bf16 v[32:35], v[140:143], v[252:255], v[32:35]
    s_mov_b32 exec_lo, 0
    s_nop 6
    v_mov_b32 v28, v32
    v_mov_b32 v29, v33
    v_mov_b32 v30, v34
    v_mov_b32 v31, v35
    s_mov_b32 exec_lo, -1
    v_permlane32_swap_b32 v28, v30
    v_permlane32_swap_b32 v29, v31
    v_add_f32 v52, v28, v30
    v_add_f32 v53, v29, v31
    ds_write_b64 v50, v[52:53] offset:1024
    v_mov_b32 v40, 0
    v_mov_b32 v41, 1
    s_mov_b64 exec, 1
    ds_add_rtn_u32 v42, v40, v41 offset:8
    s_mov_b64 exec, -1
    s_waitcnt lgkmcnt(0)
    v_readfirstlane_b32 s38, v42
    s_cmp_lg_u32 s38, 3
    s_nop 2
    s_cbranch_scc1 L_qpoll
    ds_read_b64 v[184:185], v48 offset:1024
    ds_read_b64 v[186:187], v48 offset:1536
    ds_read_b64 v[188:189], v48 offset:2048
    ds_read_b64 v[190:191], v48 offset:2560
    v_mov_b32 v53, s47
    s_waitcnt lgkmcnt(0)
    v_add_f32 v184, v184, v186
    v_add_f32 v185, v185, v187
    v_add_f32 v188, v188, v190
    v_add_f32 v189, v189, v191
    v_add_f32 v184, v184, v188
    v_add_f32 v185, v185, v189
    s_cmp_lt_u32 s49, 3
    s_cbranch_scc1 L_pubq
    s_waitcnt vmcnt(0)
    v_cvt_pk_bf16_f32 v184, v184, v184
    v_and_b32 v184, 0xffff0000, v184
    v_cvt_pk_bf16_f32 v185, v185, v185
    v_and_b32 v185, 0xffff0000, v185
    v_lshlrev_b32 v18, 16, v18
    v_lshlrev_b32 v19, 16, v19
    v_add_f32 v184, v184, v18
    v_add_f32 v185, v185, v19
    v_cvt_pk_bf16_f32 v184, v184, v184
    v_and_b32 v184, 0xffff0000, v184
    v_cvt_pk_bf16_f32 v185, v185, v185
    v_and_b32 v185, 0xffff0000, v185
    v_cmp_lt_f32 vcc, 0, v184
    s_nop 1
    v_cndmask_b32 v184, 0, v184, vcc
    v_cmp_lt_f32 vcc, 0, v185
    s_nop 1
    v_cndmask_b32 v185, 0, v185, vcc
    v_mul_f32 v184, v184, v184
    v_mul_f32 v185, v185, v185
L_pubq:
    v_cvt_pk_bf16_f32 v52, v184, v185
    global_store_dwordx2 v51, v[52:53], s[88:89] sc1
L_qpoll:
    s_cmp_eq_u32 s29, 3
    s_cbranch_scc1 L_hbar
    s_and_b32 s38, s4, 1
    v_xor_b32 v10, s38, v4
    v_mul_u32_u24 v10, 192, v10
    v_add_u32 v10, v10, v3
    s_lshl_b32 s38, s29, 7
    v_lshl_add_u32 v10, v10, 1, s38
    s_mul_i32 s38, s4, 3
    s_add_u32 s38, s38, s29
    s_lshl_b32 s38, s38, 9
    v_lshl_add_u32 v5, v1, 3, s38
    s_mov_b32 s40, 200000
L_pollQ:
    global_load_dwordx2 v[20:21], v5, s[88:89] sc1
    s_waitcnt vmcnt(0)
    v_cmp_ne_u32 vcc, s47, v21
    s_nop 0
    s_cbranch_vccz L_pollQ_done
    s_mov_b64 exec, vcc
    s_sleep 16
    s_sub_u32 s40, s40, 1
    s_cmp_lg_u32 s40, 0
    s_cbranch_scc1 L_pollQ
L_pollQ_done:
    s_mov_b64 exec, -1
    ds_write_b16 v10, v20 offset:64
    ds_write_b16_d16_hi v10, v20 offset:80
    s_waitcnt lgkmcnt(0)
L_hbar:
    s_barrier
    v_mov_b32 v12, 0xffffff00
    s_cmp_eq_u32 s6, 3
    s_cbranch_scc1 L_claim
    s_cmp_eq_u32 s6, 2
    s_cbranch_scc1 L_reducer
    s_cmp_eq_u32 s6, 1
    s_cbranch_scc1 L_ffn2
    s_cmp_eq_u32 s45, 0
    s_cbranch_scc1 L_havetile
    s_mov_b32 s16, s72
    s_mov_b32 s17, s73
    s_mov_b32 s18, 7864320
    s_mul_i32 s36, s4, 245760
    s_lshl_b32 s37, s24, 8
    s_add_u32 s36, s36, s37
    v_lshrrev_b32 v7, 4, v1
    v_mul_u32_u24 v7, 10240, v7
    v_and_b32 v8, 15, v1
    v_lshl_add_u32 v7, v8, 4, v7
    s_mul_i32 s37, s29, 12
    s_add_u32 s38, s37, 0
    s_lshr_b32 s39, s38, 3
    s_lshl_b32 s39, s39, 5
    s_and_b32 s38, s38, 7
    s_add_u32 s38, s38, s39
    s_mul_i32 s38, s38, 1280
    s_add_u32 s38, s38, s36
    buffer_load_dwordx4 v[160:163], v7, s[16:19], s38 offen nt
    s_add_u32 s38, s37, 1
    s_lshr_b32 s39, s38, 3
    s_lshl_b32 s39, s39, 5
    s_and_b32 s38, s38, 7
    s_add_u32 s38, s38, s39
    s_mul_i32 s38, s38, 1280
    s_add_u32 s38, s38, s36
    buffer_load_dwordx4 v[164:167], v7, s[16:19], s38 offen nt
    s_add_u32 s38, s37, 2
    s_lshr_b32 s39, s38, 3
    s_lshl_b32 s39, s39, 5
    s_and_b32 s38, s38, 7
    s_add_u32 s38, s38, s39
    s_mul_i32 s38, s38, 1280
    s_add_u32 s38, s38, s36
    buffer_load_dwordx4 v[168:171], v7, s[16:19], s38 offen nt
    s_add_u32 s38, s37, 3
    s_lshr_b32 s39, s38, 3
    s_lshl_b32 s39, s39, 5
    s_and_b32 s38, s38, 7
    s_add_u32 s38, s38, s39
    s_mul_i32 s38, s38, 1280
    s_add_u32 s38, s38, s36
    buffer_load_dwordx4 v[172:175], v7, s[16:19], s38 offen nt
    s_add_u32 s38, s37, 4
    s_lshr_b32 s39, s38, 3
    s_lshl_b32 s39, s39, 5
    s_and_b32 s38, s38, 7
    s_add_u32 s38, s38, s39
    s_mul_i32 s38, s38, 1280
    s_add_u32 s38, s38, s36
    buffer_load_dwordx4 v[176:179], v7, s[16:19], s38 offen nt
    s_add_u32 s38, s37, 5
    s_lshr_b32 s39, s38, 3
    s_lshl_b32 s39, s39, 5
    s_and_b32 s38, s38, 7
    s_add_u32 s38, s38, s39
    s_mul_i32 s38, s38, 1280
    s_add_u32 s38, s38, s36
    buffer_load_dwordx4 v[180:183], v7, s[16:19], s38 offen nt
    s_add_u32 s38, s37, 6
    s_lshr_b32 s39, s38, 3
    s_lshl_b32 s39, s39, 5
    s_and_b32 s38, s38, 7
    s_add_u32 s38, s38, s39
    s_mul_i32 s38, s38, 1280
    s_add_u32 s38, s38, s36
    s_waitcnt vmcnt(5)
    buffer_load_dwordx4 v[184:187], v7, s[16:19], s38 offen nt
L_havetile:
    s_lshl_b32 s38, s4, 14
    s_add_u32 s38, s38, 1048576
    s_lshl_b32 s39, s29, 8
    s_add_u32 s38, s38, s39
    v_lshrrev_b32 v2, 3, v1
    v_lshl_add_u32 v2, v2, 11, s38
    v_and_b32 v3, 7, v1
    v_lshl_add_u32 v4, v3, 4, v2
    v_min_u32 v5, 4, v3
    v_lshl_add_u32 v5, v5, 4, v2
    s_lshl_b32 s39, s29, 9
    s_add_u32 s39, s39, 1024
    v_lshrrev_b32 v7, 4, v1
    v_lshl_add_u32 v7, v7, 7, s39
    v_lshl_add_u32 v8, v3, 2, v7
    s_and_b32 s39, s4, 1
    s_lshl_b32 s39, s39, 6
    v_add_u32 v8, s39, v8
    v_xor_b32 v6, 64, v8
    v_bfe_u32 v9, v1, 3, 1
    v_lshl_add_u32 v9, v9, 6, v7
    s_lshl_b32 s38, s29, 10
    v_lshl_add_u32 v10, v1, 4, s38
    v_lshl_add_u32 v11, v1, 4, s7
    s_lshl_b32 s39, s39, 1
    v_xor_b32 v11, s39, v11
    s_waitcnt vmcnt(0)
    v_mov_b32 v28, 0
    v_mov_b32 v29, 0
    v_mov_b32 v30, 0
    v_mov_b32 v31, 0
    s_cmp_lg_u32 s29, 3
    s_cbranch_scc1 L_cdone0
    v_mov_b32 v13, 8
    v_subrev_u32 v17, 0, v1
    v_med3_i32 v17, v17, 0, 8
    v_mad_u32_u24 v13, v17, 7, v13
    v_subrev_u32 v17, 8, v1
    v_med3_i32 v17, v17, 0, 8
    v_mad_u32_u24 v13, v17, 4, v13
    v_subrev_u32 v17, 16, v1
    v_med3_i32 v17, v17, 0, 8
    v_mad_u32_u24 v13, v17, 2, v13
    v_subrev_u32 v17, 24, v1
    v_med3_i32 v17, v17, 0, 16
    v_mad_u32_u24 v13, v17, 1, v13
    s_mul_i32 s50, s4, 4352
    s_add_u32 s50, s50, 3149824
    v_mov_b32 v14, s50
    v_mov_b32 v15, 1
    v_mov_b32 v16, 0
    s_mov_b32 s50, 1
    s_mov_b32 s51, 0
    v_lshrrev_b32 v20, 4, v1
    v_mul_u32_u24 v20, 192, v20
    v_and_b32 v21, 15, v1
    v_min_u32 v21, 11, v21
    v_lshl_add_u32 v20, v21, 4, v20
    v_mov_b32 v21, 0
    s_lshl_b32 s58, s2, 1
    s_add_u32 s58, s58, 0
    s_lshl_b32 s58, s58, 10
    s_add_u32 s58, s58, 1048576
    v_lshl_add_u32 v22, v1, 4, s58
    s_mov_b32 s40, 200000
L_cmid0:
    s_sleep 16
    ds_read_b32 v17, v16 offset:16
    s_waitcnt lgkmcnt(0)
    v_readfirstlane_b32 s52, v17
    s_sub_u32 s40, s40, 1
    s_cmp_eq_u32 s40, 0
    s_nop 1
    s_cbranch_scc1 L_cdone0
    s_cmp_lt_u32 s52, 4
    s_cbranch_scc1 L_cmid0
    ds_read_b128 v[96:99], v21 offset:896
    ds_read_b128 v[100:103], v21 offset:912
    ds_read_b128 v[64:67], v20 offset:8192
    ds_read_b128 v[68:71], v20 offset:8960
    ds_read_b128 v[72:75], v20 offset:9728
    ds_read_b128 v[76:79], v20 offset:10496
    ds_read_b128 v[80:83], v20 offset:11264
    ds_read_b128 v[84:87], v20 offset:12032
    ds_read_b128 v[88:91], v20 offset:12800
    ds_read_b128 v[92:95], v20 offset:13568
    v_mov_b32 v106, 0xffffff00
    s_waitcnt lgkmcnt(8)
    v_max3_f32 v104, v96, v98, v100
    v_max_f32 v104, v104, v102
    v_sub_f32 v96, v96, v104
    v_sub_f32 v98, v98, v104
    v_sub_f32 v100, v100, v104
    v_sub_f32 v102, v102, v104
    v_exp_f32 v96, v96
    v_exp_f32 v98, v98
    v_exp_f32 v100, v100
    v_exp_f32 v102, v102
    v_mul_f32 v105, v96, v97
    v_fma_f32 v105, v98, v99, v105
    v_fma_f32 v105, v100, v101, v105
    v_fma_f32 v105, v102, v103, v105
    v_lshlrev_b32 v107, 8, v104
    v_lshlrev_b32 v108, 8, v105
    s_waitcnt lgkmcnt(0)
    v_add_f32 v64, v64, v68
    v_add_f32 v65, v65, v69
    v_add_f32 v66, v66, v70
    v_add_f32 v67, v67, v71
    v_add_f32 v72, v72, v76
    v_add_f32 v73, v73, v77
    v_add_f32 v74, v74, v78
    v_add_f32 v75, v75, v79
    v_add_f32 v80, v80, v84
    v_add_f32 v81, v81, v85
    v_add_f32 v82, v82, v86
    v_add_f32 v83, v83, v87
    v_add_f32 v88, v88, v92
    v_add_f32 v89, v89, v93
    v_add_f32 v90, v90, v94
    v_add_f32 v91, v91, v95
    v_mul_f32 v64, v64, v96
    v_mul_f32 v65, v65, v96
    v_mul_f32 v66, v66, v96
    v_mul_f32 v67, v67, v96
    v_fma_f32 v64, v72, v98, v64
    v_fma_f32 v65, v73, v98, v65
    v_fma_f32 v66, v74, v98, v66
    v_fma_f32 v67, v75, v98, v67
    v_fma_f32 v64, v80, v100, v64
    v_fma_f32 v65, v81, v100, v65
    v_fma_f32 v66, v82, v100, v66
    v_fma_f32 v67, v83, v100, v67
    v_fma_f32 v64, v88, v102, v64
    v_fma_f32 v65, v89, v102, v65
    v_fma_f32 v66, v90, v102, v66
    v_fma_f32 v67, v91, v102, v67
    s_mov_b32 exec_lo, 0x10001000
    s_mov_b32 exec_hi, 0x10001000
    v_mov_b32 v64, v104
    v_mov_b32 v65, v105
    v_mov_b32 v66, v107
    v_mov_b32 v67, v108
    s_mov_b64 exec, -1
    v_and_or_b32 v64, v64, v106, s20
    v_and_or_b32 v65, v65, v106, s21
    v_and_or_b32 v66, v66, v106, s22
    v_and_or_b32 v67, v67, v106, s23
    s_mov_b32 s59, 32
    s_mov_b64 exec, -1
    s_mov_b64 exec, 1
    s_mov_b32 s40, 200000
L_ctag0:
    global_load_dwordx2 v[18:19], v14, s[88:89] sc1
    s_waitcnt vmcnt(0)
    v_cmp_ne_u32 vcc, s47, v19
    s_nop 0
    s_cbranch_vccz L_ctag0_done
    s_mov_b64 exec, vcc
    s_sleep 8
    s_sub_u32 s40, s40, 1
    s_cmp_lg_u32 s40, 0
    s_cbranch_scc1 L_ctag0
L_ctag0_done:
    s_mov_b64 exec, -1
    s_mov_b32 s40, 200000
L_cidle0:
    s_sleep 8
    ds_read_b32 v17, v16 offset:0
    s_waitcnt lgkmcnt(0)
    v_readfirstlane_b32 s52, v17
    s_sub_u32 s40, s40, 1
    s_cmp_eq_u32 s40, 0
    s_nop 1
    s_cbranch_scc1 L_cdone0
    s_cmp_lt_i32 s52, 0
    s_cbranch_scc1 L_cidle0
L_cwait0:
    ds_read_b32 v17, v16 offset:0
    s_waitcnt lgkmcnt(0)
    v_readfirstlane_b32 s52, v17
    s_cmp_ge_u32 s52, s51
    s_nop 2
    s_cbranch_scc1 L_cgo0
    s_sleep 1
    s_sub_u32 s40, s40, 1
    s_cmp_lg_u32 s40, 0
    s_cbranch_scc1 L_cwait0
    s_branch L_cdone0
L_cgo0:
    s_mov_b64 exec, 1
    global_atomic_add v17, v14, v15, s[88:89] sc0 sc1
    s_mov_b64 exec, -1
    v_add_u32 v18, s50, v1
    v_lshlrev_b32 v18, 2, v18
    s_cmp_lg_u32 s59, 98
    s_cbranch_scc1 L_cw00
    global_store_dwordx4 v22, v[64:67], s[88:89] sc1
    s_mov_b32 s59, 99
    s_waitcnt vmcnt(1)
    s_branch L_cw10
L_cw00:
    s_waitcnt vmcnt(0)
L_cw10:
    v_readfirstlane_b32 s52, v17
    s_nop 0
    s_min_u32 s52, s52, 62
    s_add_u32 s57, s52, 1
    s_nop 0
    v_readlane_b32 s56, v13, s52
    v_readlane_b32 s57, v13, s57
    s_nop 0
    v_add_u32 v17, s56, v1
    s_sub_u32 s57, s57, s56
    s_max_u32 s58, s57, 1
    s_bfm_b64 exec, s58, 0
    ds_write_b32 v18, v17 offset:25600
    s_mov_b64 exec, -1
    s_cmp_lt_u32 s52, s59
    s_cbranch_scc1 L_cnp0
    s_mov_b32 s59, 98
    s_cmp_lg_u32 s57, 0
    s_cbranch_scc1 L_cnp0
    s_mov_b32 s59, 99
    global_store_dwordx4 v22, v[64:67], s[88:89] sc1
L_cnp0:
    s_add_u32 s50, s50, s57
    s_cmp_ge_u32 s57, 3
    s_cselect_b32 s58, 2, 1
    s_sub_u32 s51, s50, s58
    s_cmp_lg_u32 s57, 0
    s_cbranch_scc1 L_cwait0
L_cdone0:
    v_mov_b32 v16, 0
    s_mov_b32 s40, 200000
L_wl0:
    ds_read_b32 v17, v16 offset:0
    s_waitcnt lgkmcnt(0)
    v_readfirstlane_b32 s52, v17
    s_cmp_ge_i32 s52, 0
    s_nop 2
    s_cbranch_scc1 L_wl0_done
    s_sleep 64
    s_sub_u32 s40, s40, 1
    s_cmp_lg_u32 s40, 0
    s_cbranch_scc1 L_wl0
L_wl0_done:
    s_mov_b32 s16, s72
    s_mov_b32 s17, s73
    s_mov_b32 s18, 7864320
    s_mul_i32 s36, s4, 245760
    s_lshl_b32 s37, s24, 8
    s_add_u32 s36, s36, s37
    v_lshrrev_b32 v23, 4, v1
    v_mul_u32_u24 v23, 10240, v23
    v_and_b32 v17, 15, v1
    v_lshl_add_u32 v23, v17, 4, v23
    s_mul_i32 s37, s29, 12
    s_add_u32 s38, s37, 7
    s_lshr_b32 s39, s38, 3
    s_lshl_b32 s39, s39, 5
    s_and_b32 s38, s38, 7
    s_add_u32 s38, s38, s39
    s_mul_i32 s38, s38, 1280
    s_add_u32 s57, s38, s36
    s_add_u32 s38, s37, 8
    s_lshr_b32 s39, s38, 3
    s_lshl_b32 s39, s39, 5
    s_and_b32 s38, s38, 7
    s_add_u32 s38, s38, s39
    s_mul_i32 s38, s38, 1280
    s_add_u32 s58, s38, s36
    s_add_u32 s38, s37, 9
    s_lshr_b32 s39, s38, 3
    s_lshl_b32 s39, s39, 5
    s_and_b32 s38, s38, 7
    s_add_u32 s38, s38, s39
    s_mul_i32 s38, s38, 1280
    s_add_u32 s59, s38, s36
    s_add_u32 s38, s37, 10
    s_lshr_b32 s39, s38, 3
    s_lshl_b32 s39, s39, 5
    s_and_b32 s38, s38, 7
    s_add_u32 s38, s38, s39
    s_mul_i32 s38, s38, 1280
    s_add_u32 s41, s38, s36
    s_add_u32 s38, s37, 11
    s_lshr_b32 s39, s38, 3
    s_lshl_b32 s39, s39, 5
    s_and_b32 s38, s38, 7
    s_add_u32 s38, s38, s39
    s_mul_i32 s38, s38, 1280
    s_add_u32 s42, s38, s36
    s_mov_b32 s40, 200000
L_wl1:
    ds_read_b32 v17, v16 offset:0
    s_waitcnt lgkmcnt(0)
    v_readfirstlane_b32 s38, v17
    s_cmp_eq_u32 s38, 0x7fffffff
    s_nop 2
    s_cbranch_scc1 L_wl1_done
    s_sleep 2
    s_sub_u32 s40, s40, 1
    s_cmp_lg_u32 s40, 0
    s_cbranch_scc1 L_wl1
L_wl1_done:
    buffer_load_dwordx4 v[188:191], v23, s[16:19], s57 offen nt
    buffer_load_dwordx4 v[192:195], v23, s[16:19], s58 offen nt
    s_barrier
    s_branch L_a0
L_a0w:
    v_mov_b32 v16, 0
    s_mov_b32 s40, 200000
L_a0i:
    s_sleep 64
    ds_read_b32 v17, v16 offset:0
    s_waitcnt lgkmcnt(0)
    v_readfirstlane_b32 s52, v17
    s_sub_u32 s40, s40, 1
    s_cmp_eq_u32 s40, 0
    s_nop 1
    s_cbranch_scc1 L_a0
    s_cmp_lt_i32 s52, 0
    s_cbranch_scc1 L_a0i
L_a0:
    s_mov_b32 s40, 200000
    global_load_dwordx4 v[112:115], v4, s[88:89] offset:0 sc1
    global_load_dwordx4 v[116:119], v5, s[88:89] offset:128 sc1
    buffer_load_dwordx4 v[196:199], v23, s[16:19], s59 offen nt
    buffer_load_dwordx4 v[200:203], v23, s[16:19], s41 offen nt
    buffer_load_dwordx4 v[204:207], v23, s[16:19], s42 offen nt
    s_waitcnt vmcnt(3)
    s_branch L_pollA0_chk
L_pollA0:
    global_load_dwordx4 v[112:115], v4, s[88:89] offset:0 sc1
    global_load_dwordx4 v[116:119], v5, s[88:89] offset:128 sc1
    s_waitcnt vmcnt(0)
L_pollA0_chk:
    v_xor_b32 v112, s20, v112
    v_xor_b32 v113, s21, v113
    v_xor_b32 v114, s22, v114
    v_xor_b32 v115, s23, v115
    v_xor_b32 v116, s20, v116
    v_xor_b32 v117, s21, v117
    v_xor_b32 v118, s22, v118
    v_xor_b32 v119, s23, v119
    v_or3_b32 v40, v112, v113, v114
    v_or3_b32 v40, v40, v115, v116
    v_or3_b32 v40, v40, v117, v118
    v_or_b32 v40, v40, v119
    v_and_b32 v40, 0xff, v40
    v_cmp_ne_u32 vcc, 0, v40
    s_nop 0
    s_cbranch_vccz L_pollA0_done
    s_mov_b64 exec, vcc
    s_sleep 2
    s_sub_u32 s40, s40, 1
    s_cmp_lg_u32 s40, 0
    s_cbranch_scc1 L_pollA0
L_pollA0_done:
    s_mov_b64 exec, -1
L_a1:
    s_mov_b32 s40, 200000
L_pollA:
    global_load_dwordx4 v[208:211], v4, s[88:89] offset:1024 sc1
    global_load_dwordx4 v[212:215], v5, s[88:89] offset:1152 sc1
    v_bfe_u32 v120, v118, 8, 8
    v_bfe_u32 v121, v119, 8, 8
    v_or_b32 v120, v120, v116
    v_or_b32 v121, v121, v117
    s_nop 0
    v_mov_b32_dpp v120, v120 row_half_mirror row_mask:0xf bank_mask:0x5
    v_mov_b32_dpp v121, v121 row_half_mirror row_mask:0xf bank_mask:0x5
    v_mov_b32 v122, v120
    s_nop 1
    v_max_f32_dpp v122, v122, v122 row_ror:8 row_mask:0xf bank_mask:0xf
    v_mov_b32 v123, v122
    s_nop 1
    v_permlane16_swap_b32 v122, v123
    v_max_f32 v122, v122, v123
    v_mov_b32 v123, v122
    s_nop 1
    v_permlane32_swap_b32 v122, v123
    v_max_f32 v122, v122, v123
    v_sub_f32 v120, v120, v122
    v_exp_f32 v120, v120
    s_nop 0
    v_mul_f32 v121, v121, v120
    v_mul_f32 v112, v112, v120
    v_mul_f32 v113, v113, v120
    v_mul_f32 v114, v114, v120
    v_mul_f32 v115, v115, v120
    v_mul_f32 v116, v116, v120
    v_mul_f32 v117, v117, v120
    v_mul_f32 v118, v118, v120
    v_mul_f32 v119, v119, v120
    v_add_f32_dpp v121, v121, v121 row_ror:8 row_mask:0xf bank_mask:0xf
    v_mov_b32 v123, v121
    s_nop 1
    v_permlane16_swap_b32 v121, v123
    v_add_f32 v121, v121, v123
    v_mov_b32 v123, v121
    s_nop 1
    v_permlane32_swap_b32 v121, v123
    v_add_f32 v121, v121, v123
    v_rcp_f32 v121, v121
    v_permlane32_swap_b32 v112, v114
    v_permlane32_swap_b32 v113, v115
    v_permlane32_swap_b32 v116, v118
    v_permlane32_swap_b32 v117, v119
    v_add_f32 v112, v112, v114
    v_add_f32 v113, v113, v115
    v_add_f32 v116, v116, v118
    v_add_f32 v117, v117, v119
    v_permlane16_swap_b32 v112, v113
    s_nop 0
    v_permlane16_swap_b32 v116, v117
    v_add_f32 v112, v112, v113
    v_add_f32 v116, v116, v117
    s_nop 0
    v_add_f32_dpp v112, v112, v112 row_ror:8 row_mask:0xf bank_mask:0xf
    v_add_f32_dpp v116, v116, v116 row_ror:8 row_mask:0xf bank_mask:0xf
    v_mul_f32 v112, v112, v121
    v_mul_f32 v116, v116, v121
    v_cvt_pk_bf16_f32 v112, v112, v112
    v_cvt_pk_bf16_f32 v116, v116, v116
    global_load_dwordx4 v[216:219], v4, s[88:89] offset:1024 sc1
    global_load_dwordx4 v[220:223], v5, s[88:89] offset:1152 sc1
    v_and_b32_dpp v64, v112, v24 row_newbcast:0 row_mask:0xf bank_mask:0x3
    v_and_b32_dpp v65, v112, v25 row_newbcast:0 row_mask:0xf bank_mask:0x3
    v_and_b32_dpp v66, v112, v26 row_newbcast:0 row_mask:0xf bank_mask:0x3
    v_and_b32_dpp v67, v112, v27 row_newbcast:0 row_mask:0xf bank_mask:0x3
    v_and_b32_dpp v68, v112, v24 row_newbcast:1 row_mask:0xf bank_mask:0x3
    v_and_b32_dpp v69, v112, v25 row_newbcast:1 row_mask:0xf bank_mask:0x3
    v_and_b32_dpp v70, v112, v26 row_newbcast:1 row_mask:0xf bank_mask:0x3
    v_and_b32_dpp v71, v112, v27 row_newbcast:1 row_mask:0xf bank_mask:0x3
    v_and_b32_dpp v72, v112, v24 row_newbcast:2 row_mask:0xf bank_mask:0x3
    v_and_b32_dpp v73, v112, v25 row_newbcast:2 row_mask:0xf bank_mask:0x3
    v_and_b32_dpp v74, v112, v26 row_newbcast:2 row_mask:0xf bank_mask:0x3
    v_and_b32_dpp v75, v112, v27 row_newbcast:2 row_mask:0xf bank_mask:0x3
    v_and_b32_dpp v76, v112, v24 row_newbcast:3 row_mask:0xf bank_mask:0x3
    v_and_b32_dpp v77, v112, v25 row_newbcast:3 row_mask:0xf bank_mask:0x3
    v_and_b32_dpp v78, v112, v26 row_newbcast:3 row_mask:0xf bank_mask:0x3
    v_and_b32_dpp v79, v112, v27 row_newbcast:3 row_mask:0xf bank_mask:0x3
    v_and_b32_dpp v80, v112, v24 row_newbcast:4 row_mask:0xf bank_mask:0x3
    v_and_b32_dpp v81, v112, v25 row_newbcast:4 row_mask:0xf bank_mask:0x3
    v_and_b32_dpp v82, v112, v26 row_newbcast:4 row_mask:0xf bank_mask:0x3
    v_and_b32_dpp v83, v112, v27 row_newbcast:4 row_mask:0xf bank_mask:0x3
    v_and_b32_dpp v84, v112, v24 row_newbcast:5 row_mask:0xf bank_mask:0x3
    v_and_b32_dpp v85, v112, v25 row_newbcast:5 row_mask:0xf bank_mask:0x3
    v_and_b32_dpp v86, v112, v26 row_newbcast:5 row_mask:0xf bank_mask:0x3
    v_and_b32_dpp v87, v112, v27 row_newbcast:5 row_mask:0xf bank_mask:0x3
    v_and_b32_dpp v88, v112, v24 row_newbcast:6 row_mask:0xf bank_mask:0x3
    v_and_b32_dpp v89, v112, v25 row_newbcast:6 row_mask:0xf bank_mask:0x3
    v_and_b32_dpp v90, v112, v26 row_newbcast:6 row_mask:0xf bank_mask:0x3
    v_and_b32_dpp v91, v112, v27 row_newbcast:6 row_mask:0xf bank_mask:0x3
    v_and_b32_dpp v92, v112, v24 row_newbcast:7 row_mask:0xf bank_mask:0x3
    v_and_b32_dpp v93, v112, v25 row_newbcast:7 row_mask:0xf bank_mask:0x3
    v_and_b32_dpp v94, v112, v26 row_newbcast:7 row_mask:0xf bank_mask:0x3
    v_and_b32_dpp v95, v112, v27 row_newbcast:7 row_mask:0xf bank_mask:0x3
    v_and_b32_dpp v96, v116, v24 row_newbcast:0 row_mask:0xf bank_mask:0x3
    v_and_b32_dpp v97, v116, v25 row_newbcast:0 row_mask:0xf bank_mask:0x3
    v_and_b32_dpp v98, v116, v26 row_newbcast:0 row_mask:0xf bank_mask:0x3
    v_and_b32_dpp v99, v116, v27 row_newbcast:0 row_mask:0xf bank_mask:0x3
    v_and_b32_dpp v100, v116, v24 row_newbcast:1 row_mask:0xf bank_mask:0x3
    v_and_b32_dpp v101, v116, v25 row_newbcast:1 row_mask:0xf bank_mask:0x3
    v_and_b32_dpp v102, v116, v26 row_newbcast:1 row_mask:0xf bank_mask:0x3
    v_and_b32_dpp v103, v116, v27 row_newbcast:1 row_mask:0xf bank_mask:0x3
    v_and_b32_dpp v104, v116, v24 row_newbcast:2 row_mask:0xf bank_mask:0x3
    v_and_b32_dpp v105, v116, v25 row_newbcast:2 row_mask:0xf bank_mask:0x3
    v_and_b32_dpp v106, v116, v26 row_newbcast:2 row_mask:0xf bank_mask:0x3
    v_and_b32_dpp v107, v116, v27 row_newbcast:2 row_mask:0xf bank_mask:0x3
    v_and_b32_dpp v108, v116, v24 row_newbcast:3 row_mask:0xf bank_mask:0x3
    v_and_b32_dpp v109, v116, v25 row_newbcast:3 row_mask:0xf bank_mask:0x3
    v_and_b32_dpp v110, v116, v26 row_newbcast:3 row_mask:0xf bank_mask:0x3
    v_and_b32_dpp v111, v116, v27 row_newbcast:3 row_mask:0xf bank_mask:0x3
L_pollA_loop:
    global_load_dwordx4 v[224:227], v4, s[88:89] offset:1024 sc1
    global_load_dwordx4 v[228:231], v5, s[88:89] offset:1152 sc1
    s_waitcnt vmcnt(4)
    v_xor_b32 v112, s20, v208
    v_xor_b32 v113, s21, v209
    v_xor_b32 v114, s22, v210
    v_xor_b32 v115, s23, v211
    v_xor_b32 v116, s20, v212
    v_xor_b32 v117, s21, v213
    v_xor_b32 v118, s22, v214
    v_xor_b32 v119, s23, v215
    v_or3_b32 v40, v112, v113, v114
    v_or3_b32 v40, v40, v115, v116
    v_or3_b32 v40, v40, v117, v118
    v_or_b32 v40, v40, v119
    v_and_b32 v40, 0xff, v40
    v_cmp_ne_u32 vcc, 0, v40
    s_nop 0
    s_cbranch_vccz L_pollA_done
    s_mov_b64 exec, vcc
    global_load_dwordx4 v[208:211], v4, s[88:89] offset:1024 sc1
    global_load_dwordx4 v[212:215], v5, s[88:89] offset:1152 sc1
    s_waitcnt vmcnt(4)
    v_xor_b32 v112, s20, v216
    v_xor_b32 v113, s21, v217
    v_xor_b32 v114, s22, v218
    v_xor_b32 v115, s23, v219
    v_xor_b32 v116, s20, v220
    v_xor_b32 v117, s21, v221
    v_xor_b32 v118, s22, v222
    v_xor_b32 v119, s23, v223
    v_or3_b32 v40, v112, v113, v114
    v_or3_b32 v40, v40, v115, v116
    v_or3_b32 v40, v40, v117, v118
    v_or_b32 v40, v40, v119
    v_and_b32 v40, 0xff, v40
    v_cmp_ne_u32 vcc, 0, v40
    s_nop 0
    s_cbranch_vccz L_pollA_done
    s_mov_b64 exec, vcc
    global_load_dwordx4 v[216:219], v4, s[88:89] offset:1024 sc1
    global_load_dwordx4 v[220:223], v5, s[88:89] offset:1152 sc1
    s_waitcnt vmcnt(4)
    v_xor_b32 v112, s20, v224
    v_xor_b32 v113, s21, v225
    v_xor_b32 v114, s22, v226
    v_xor_b32 v115, s23, v227
    v_xor_b32 v116, s20, v228
    v_xor_b32 v117, s21, v229
    v_xor_b32 v118, s22, v230
    v_xor_b32 v119, s23, v231
    v_or3_b32 v40, v112, v113, v114
    v_or3_b32 v40, v40, v115, v116
    v_or3_b32 v40, v40, v117, v118
    v_or_b32 v40, v40, v119
    v_and_b32 v40, 0xff, v40
    v_cmp_ne_u32 vcc, 0, v40
    s_nop 0
    s_cbranch_vccz L_pollA_done
    s_mov_b64 exec, vcc
    s_sub_u32 s40, s40, 1
    s_cmp_lg_u32 s40, 0
    s_cbranch_scc1 L_pollA_loop
L_pollA_done:
    s_mov_b64 exec, -1
    v_bfe_u32 v120, v118, 8, 8
    v_bfe_u32 v121, v119, 8, 8
    v_or_b32 v120, v120, v116
    v_or_b32 v121, v121, v117
    s_nop 0
    v_mov_b32_dpp v120, v120 row_half_mirror row_mask:0xf bank_mask:0x5
    v_mov_b32_dpp v121, v121 row_half_mirror row_mask:0xf bank_mask:0x5
    v_mov_b32 v122, v120
    s_nop 1
    v_max_f32_dpp v122, v122, v122 row_ror:8 row_mask:0xf bank_mask:0xf
    v_mov_b32 v123, v122
    s_nop 1
    v_permlane16_swap_b32 v122, v123
    v_max_f32 v122, v122, v123
    v_mov_b32 v123, v122
    s_nop 1
    v_permlane32_swap_b32 v122, v123
    v_max_f32 v122, v122, v123
    v_sub_f32 v120, v120, v122
    v_exp_f32 v120, v120
    s_nop 0
    v_mul_f32 v121, v121, v120
    v_mul_f32 v112, v112, v120
    v_mul_f32 v113, v113, v120
    v_mul_f32 v114, v114, v120
    v_mul_f32 v115, v115, v120
    v_mul_f32 v116, v116, v120
    v_mul_f32 v117, v117, v120
    v_mul_f32 v118, v118, v120
    v_mul_f32 v119, v119, v120
    v_add_f32_dpp v121, v121, v121 row_ror:8 row_mask:0xf bank_mask:0xf
    v_mov_b32 v123, v121
    s_nop 1
    v_permlane16_swap_b32 v121, v123
    v_add_f32 v121, v121, v123
    v_mov_b32 v123, v121
    s_nop 1
    v_permlane32_swap_b32 v121, v123
    v_add_f32 v121, v121, v123
    v_rcp_f32 v121, v121
    v_permlane32_swap_b32 v112, v114
    v_permlane32_swap_b32 v113, v115
    v_permlane32_swap_b32 v116, v118
    v_permlane32_swap_b32 v117, v119
    v_add_f32 v112, v112, v114
    v_add_f32 v113, v113, v115
    v_add_f32 v116, v116, v118
    v_add_f32 v117, v117, v119
    v_permlane16_swap_b32 v112, v113
    s_nop 0
    v_permlane16_swap_b32 v116, v117
    v_add_f32 v112, v112, v113
    v_add_f32 v116, v116, v117
    s_nop 0
    v_add_f32_dpp v112, v112, v112 row_ror:8 row_mask:0xf bank_mask:0xf
    v_add_f32_dpp v116, v116, v116 row_ror:8 row_mask:0xf bank_mask:0xf
    v_mul_f32 v112, v112, v121
    v_mul_f32 v116, v116, v121
    v_cvt_pk_bf16_f32 v112, v112, v112
    v_cvt_pk_bf16_f32 v116, v116, v116
    s_nop 0
    v_and_b32_dpp v64, v112, v24 row_newbcast:0 row_mask:0xf bank_mask:0xc
    v_and_b32_dpp v65, v112, v25 row_newbcast:0 row_mask:0xf bank_mask:0xc
    v_and_b32_dpp v66, v112, v26 row_newbcast:0 row_mask:0xf bank_mask:0xc
    v_and_b32_dpp v67, v112, v27 row_newbcast:0 row_mask:0xf bank_mask:0xc
    v_and_b32_dpp v68, v112, v24 row_newbcast:1 row_mask:0xf bank_mask:0xc
    v_and_b32_dpp v69, v112, v25 row_newbcast:1 row_mask:0xf bank_mask:0xc
    v_and_b32_dpp v70, v112, v26 row_newbcast:1 row_mask:0xf bank_mask:0xc
    v_and_b32_dpp v71, v112, v27 row_newbcast:1 row_mask:0xf bank_mask:0xc
    v_mfma_f32_16x16x32_bf16 v[28:31], v[160:163], v[64:67], v[28:31]
    v_and_b32_dpp v72, v112, v24 row_newbcast:2 row_mask:0xf bank_mask:0xc
    v_and_b32_dpp v73, v112, v25 row_newbcast:2 row_mask:0xf bank_mask:0xc
    v_and_b32_dpp v74, v112, v26 row_newbcast:2 row_mask:0xf bank_mask:0xc
    v_and_b32_dpp v75, v112, v27 row_newbcast:2 row_mask:0xf bank_mask:0xc
    v_mfma_f32_16x16x32_bf16 v[28:31], v[164:167], v[68:71], v[28:31]
    v_and_b32_dpp v76, v112, v24 row_newbcast:3 row_mask:0xf bank_mask:0xc
    v_and_b32_dpp v77, v112, v25 row_newbcast:3 row_mask:0xf bank_mask:0xc
    v_and_b32_dpp v78, v112, v26 row_newbcast:3 row_mask:0xf bank_mask:0xc
    v_and_b32_dpp v79, v112, v27 row_newbcast:3 row_mask:0xf bank_mask:0xc
    v_mfma_f32_16x16x32_bf16 v[28:31], v[168:171], v[72:75], v[28:31]
    v_and_b32_dpp v80, v112, v24 row_newbcast:4 row_mask:0xf bank_mask:0xc
    v_and_b32_dpp v81, v112, v25 row_newbcast:4 row_mask:0xf bank_mask:0xc
    v_and_b32_dpp v82, v112, v26 row_newbcast:4 row_mask:0xf bank_mask:0xc
    v_and_b32_dpp v83, v112, v27 row_newbcast:4 row_mask:0xf bank_mask:0xc
    v_mfma_f32_16x16x32_bf16 v[28:31], v[172:175], v[76:79], v[28:31]
    v_and_b32_dpp v84, v112, v24 row_newbcast:5 row_mask:0xf bank_mask:0xc
    v_and_b32_dpp v85, v112, v25 row_newbcast:5 row_mask:0xf bank_mask:0xc
    v_and_b32_dpp v86, v112, v26 row_newbcast:5 row_mask:0xf bank_mask:0xc
    v_and_b32_dpp v87, v112, v27 row_newbcast:5 row_mask:0xf bank_mask:0xc
    v_mfma_f32_16x16x32_bf16 v[28:31], v[176:179], v[80:83], v[28:31]
    v_and_b32_dpp v88, v112, v24 row_newbcast:6 row_mask:0xf bank_mask:0xc
    v_and_b32_dpp v89, v112, v25 row_newbcast:6 row_mask:0xf bank_mask:0xc
    v_and_b32_dpp v90, v112, v26 row_newbcast:6 row_mask:0xf bank_mask:0xc
    v_and_b32_dpp v91, v112, v27 row_newbcast:6 row_mask:0xf bank_mask:0xc
    v_mfma_f32_16x16x32_bf16 v[28:31], v[180:183], v[84:87], v[28:31]
    v_and_b32_dpp v92, v112, v24 row_newbcast:7 row_mask:0xf bank_mask:0xc
    v_and_b32_dpp v93, v112, v25 row_newbcast:7 row_mask:0xf bank_mask:0xc
    v_and_b32_dpp v94, v112, v26 row_newbcast:7 row_mask:0xf bank_mask:0xc
    v_and_b32_dpp v95, v112, v27 row_newbcast:7 row_mask:0xf bank_mask:0xc
    v_mfma_f32_16x16x32_bf16 v[28:31], v[184:187], v[88:91], v[28:31]
    v_and_b32_dpp v96, v116, v24 row_newbcast:0 row_mask:0xf bank_mask:0xc
    v_and_b32_dpp v97, v116, v25 row_newbcast:0 row_mask:0xf bank_mask:0xc
    v_and_b32_dpp v98, v116, v26 row_newbcast:0 row_mask:0xf bank_mask:0xc
    v_and_b32_dpp v99, v116, v27 row_newbcast:0 row_mask:0xf bank_mask:0xc
    v_mfma_f32_16x16x32_bf16 v[28:31], v[188:191], v[92:95], v[28:31]
    v_and_b32_dpp v100, v116, v24 row_newbcast:1 row_mask:0xf bank_mask:0xc
    v_and_b32_dpp v101, v116, v25 row_newbcast:1 row_mask:0xf bank_mask:0xc
    v_and_b32_dpp v102, v116, v26 row_newbcast:1 row_mask:0xf bank_mask:0xc
    v_and_b32_dpp v103, v116, v27 row_newbcast:1 row_mask:0xf bank_mask:0xc
    v_mfma_f32_16x16x32_bf16 v[28:31], v[192:195], v[96:99], v[28:31]
    v_and_b32_dpp v104, v116, v24 row_newbcast:2 row_mask:0xf bank_mask:0xc
    v_and_b32_dpp v105, v116, v25 row_newbcast:2 row_mask:0xf bank_mask:0xc
    v_and_b32_dpp v106, v116, v26 row_newbcast:2 row_mask:0xf bank_mask:0xc
    v_and_b32_dpp v107, v116, v27 row_newbcast:2 row_mask:0xf bank_mask:0xc
    v_mfma_f32_16x16x32_bf16 v[28:31], v[196:199], v[100:103], v[28:31]
    v_and_b32_dpp v108, v116, v24 row_newbcast:3 row_mask:0xf bank_mask:0xc
    v_and_b32_dpp v109, v116, v25 row_newbcast:3 row_mask:0xf bank_mask:0xc
    v_and_b32_dpp v110, v116, v26 row_newbcast:3 row_mask:0xf bank_mask:0xc
    v_and_b32_dpp v111, v116, v27 row_newbcast:3 row_mask:0xf bank_mask:0xc
    v_mfma_f32_16x16x32_bf16 v[28:31], v[200:203], v[104:107], v[28:31]
    s_nop 0
    v_mfma_f32_16x16x32_bf16 v[28:31], v[204:207], v[108:111], v[28:31]
    s_nop 7
    ds_write_b128 v10, v[28:31] offset:21504
    s_waitcnt lgkmcnt(0)
    s_barrier
    s_cmp_lg_u32 s29, 0
    s_cbranch_scc1 L_exit
    ds_read_b128 v[116:119], v10 offset:22528
    ds_read_b128 v[120:123], v10 offset:23552
    ds_read_b128 v[124:127], v10 offset:24576
    s_waitcnt lgkmcnt(0)
    v_add_f32 v28, v28, v116
    v_add_f32 v29, v29, v117
    v_add_f32 v30, v30, v118
    v_add_f32 v31, v31, v119
    v_add_f32 v120, v120, v124
    v_add_f32 v121, v121, v125
    v_add_f32 v122, v122, v126
    v_add_f32 v123, v123, v127
    v_add_f32 v28, v28, v120
    v_add_f32 v29, v29, v121
    v_add_f32 v30, v30, v122
    v_add_f32 v31, v31, v123
    v_and_or_b32 v28, v28, v12, s20
    v_and_or_b32 v29, v29, v12, s21
    v_and_or_b32 v30, v30, v12, s22
    v_and_or_b32 v31, v31, v12, s23
    global_store_dwordx4 v11, v[28:31], s[88:89] sc1
    s_nop 0
    s_branch L_exit
L_ffn2:
    s_cmp_eq_u32 s29, 3
    s_cbranch_scc1 L_claim
    s_mov_b32 s16, s80
    s_mov_b32 s17, s81
    s_mov_b32 s18, 1966080
    s_mul_i32 s36, s25, 192
    s_lshl_b32 s37, s29, 6
    s_add_u32 s36, s36, s37
    s_mul_i32 s36, s36, 1280
    s_lshl_b32 s37, s24, 8
    s_add_u32 s36, s36, s37
    v_lshrrev_b32 v2, 4, v1
    v_mul_u32_u24 v2, 20480, v2
    v_and_b32 v11, 15, v1
    v_lshl_add_u32 v2, v11, 4, v2
    buffer_load_dwordx4 v[160:163], v2, s[16:19], s36 offen nt
    s_add_u32 s36, s36, 1280
    buffer_load_dwordx4 v[164:167], v2, s[16:19], s36 offen nt
    s_add_u32 s36, s36, 1280
    buffer_load_dwordx4 v[168:171], v2, s[16:19], s36 offen nt
    s_add_u32 s36, s36, 1280
    buffer_load_dwordx4 v[172:175], v2, s[16:19], s36 offen nt
    s_add_u32 s36, s36, 1280
    buffer_load_dwordx4 v[176:179], v2, s[16:19], s36 offen nt
    s_add_u32 s36, s36, 1280
    buffer_load_dwordx4 v[180:183], v2, s[16:19], s36 offen nt
    s_add_u32 s36, s36, 1280
    s_waitcnt vmcnt(5)
    buffer_load_dwordx4 v[184:187], v2, s[16:19], s36 offen nt
    s_add_u32 s36, s36, 1280
    s_waitcnt vmcnt(5)
    buffer_load_dwordx4 v[188:191], v2, s[16:19], s36 offen nt
    s_add_u32 s36, s36, 1280
    s_waitcnt vmcnt(5)
    buffer_load_dwordx4 v[192:195], v2, s[16:19], s36 offen nt
    s_add_u32 s36, s36, 1280
    s_waitcnt vmcnt(5)
    buffer_load_dwordx4 v[196:199], v2, s[16:19], s36 offen nt
    s_add_u32 s36, s36, 1280
    s_waitcnt vmcnt(5)
    buffer_load_dwordx4 v[200:203], v2, s[16:19], s36 offen nt
    s_add_u32 s36, s36, 1280
    s_waitcnt vmcnt(5)
    buffer_load_dwordx4 v[204:207], v2, s[16:19], s36 offen nt
    s_add_u32 s36, s36, 1280
    s_waitcnt vmcnt(5)
    buffer_load_dwordx4 v[208:211], v2, s[16:19], s36 offen nt
    s_add_u32 s36, s36, 1280
    s_waitcnt vmcnt(5)
    buffer_load_dwordx4 v[212:215], v2, s[16:19], s36 offen nt
    s_add_u32 s36, s36, 1280
    s_waitcnt vmcnt(5)
    buffer_load_dwordx4 v[216:219], v2, s[16:19], s36 offen nt
    s_add_u32 s36, s36, 1280
    s_waitcnt vmcnt(5)
    buffer_load_dwordx4 v[220:223], v2, s[16:19], s36 offen nt
    s_add_u32 s36, s36, 1280
    s_mul_i32 s38, s25, 3
    s_add_u32 s38, s38, s29
    s_add_u32 s38, s38, 96
    s_lshl_b32 s38, s38, 9
    v_lshl_add_u32 v5, v1, 3, s38
    v_mov_b32 v16, 0
    s_mov_b32 s40, 200000
L_hd0:
    ds_read_b32 v17, v16 offset:0
    s_waitcnt lgkmcnt(0)
    v_readfirstlane_b32 s52, v17
    s_cmp_ge_i32 s52, 0
    s_nop 2
    s_cbranch_scc1 L_hd0_done
    s_sleep 64
    s_sub_u32 s40, s40, 1
    s_cmp_lg_u32 s40, 0
    s_cbranch_scc1 L_hd0
L_hd0_done:
    s_mov_b32 s40, 200000
L_pollH:
    global_load_dwordx2 v[20:21], v5, s[88:89] sc1
    s_waitcnt vmcnt(0)
    v_cmp_ne_u32 vcc, s47, v21
    s_nop 0
    s_cbranch_vccz L_pollH_done
    s_mov_b64 exec, vcc
    s_sleep 16
    s_sub_u32 s40, s40, 1
    s_cmp_lg_u32 s40, 0
    s_cbranch_scc1 L_pollH
L_pollH_done:
    s_mov_b64 exec, -1
    v_and_b32 v21, 0xffff, v20
    v_lshrrev_b32 v22, 16, v20
    v_lshl_or_b32 v21, v21, 16, v21
    v_lshl_or_b32 v22, v22, 16, v22
    s_lshl_b32 s39, s29, 9
    s_add_u32 s39, s39, 26624
    v_lshl_add_u32 v8, v4, 8, s39
    v_lshl_add_u32 v7, v3, 2, v8
    v_lshrrev_b32 v9, 4, v1
    v_lshl_add_u32 v9, v9, 6, v8
    ds_write_b32 v7, v21
    ds_write_b32 v7, v22 offset:32
    ds_read_b128 v[136:139], v9 offset:0
    ds_read_b128 v[140:143], v9 offset:16
    ds_read_b128 v[144:147], v9 offset:32
    ds_read_b128 v[148:151], v9 offset:48
    v_mov_b32 v28, 0
    v_mov_b32 v29, 0
    v_mov_b32 v30, 0
    v_mov_b32 v31, 0
    s_lshl_b32 s38, s29, 10
    v_lshlrev_b32 v13, 4, v1
    v_add_u32 v10, s38, v13
    v_add_u32 v11, s7, v13
    s_waitcnt lgkmcnt(3)
    v_and_b32 v68, v136, v24
    v_and_b32 v69, v136, v25
    v_and_b32 v70, v136, v26
    v_and_b32 v71, v136, v27
    v_and_b32 v72, v137, v24
    v_and_b32 v73, v137, v25
    v_and_b32 v74, v137, v26
    v_and_b32 v75, v137, v27
    v_mfma_f32_16x16x32_bf16 v[28:31], v[160:163], v[68:71], v[28:31]
    v_and_b32 v76, v138, v24
    v_and_b32 v77, v138, v25
    v_and_b32 v78, v138, v26
    v_and_b32 v79, v138, v27
    v_mfma_f32_16x16x32_bf16 v[28:31], v[164:167], v[72:75], v[28:31]
    v_and_b32 v80, v139, v24
    v_and_b32 v81, v139, v25
    v_and_b32 v82, v139, v26
    v_and_b32 v83, v139, v27
    v_mfma_f32_16x16x32_bf16 v[28:31], v[168:171], v[76:79], v[28:31]
    s_waitcnt lgkmcnt(2)
    v_and_b32 v84, v140, v24
    v_and_b32 v85, v140, v25
    v_and_b32 v86, v140, v26
    v_and_b32 v87, v140, v27
    v_mfma_f32_16x16x32_bf16 v[28:31], v[172:175], v[80:83], v[28:31]
    v_and_b32 v88, v141, v24
    v_and_b32 v89, v141, v25
    v_and_b32 v90, v141, v26
    v_and_b32 v91, v141, v27
    v_mfma_f32_16x16x32_bf16 v[28:31], v[176:179], v[84:87], v[28:31]
    v_and_b32 v92, v142, v24
    v_and_b32 v93, v142, v25
    v_and_b32 v94, v142, v26
    v_and_b32 v95, v142, v27
    v_mfma_f32_16x16x32_bf16 v[28:31], v[180:183], v[88:91], v[28:31]
    v_and_b32 v96, v143, v24
    v_and_b32 v97, v143, v25
    v_and_b32 v98, v143, v26
    v_and_b32 v99, v143, v27
    v_mfma_f32_16x16x32_bf16 v[28:31], v[184:187], v[92:95], v[28:31]
    s_waitcnt lgkmcnt(1)
    v_and_b32 v100, v144, v24
    v_and_b32 v101, v144, v25
    v_and_b32 v102, v144, v26
    v_and_b32 v103, v144, v27
    v_mfma_f32_16x16x32_bf16 v[28:31], v[188:191], v[96:99], v[28:31]
    v_and_b32 v104, v145, v24
    v_and_b32 v105, v145, v25
    v_and_b32 v106, v145, v26
    v_and_b32 v107, v145, v27
    v_mfma_f32_16x16x32_bf16 v[28:31], v[192:195], v[100:103], v[28:31]
    v_and_b32 v108, v146, v24
    v_and_b32 v109, v146, v25
    v_and_b32 v110, v146, v26
    v_and_b32 v111, v146, v27
    v_mfma_f32_16x16x32_bf16 v[28:31], v[196:199], v[104:107], v[28:31]
    v_and_b32 v112, v147, v24
    v_and_b32 v113, v147, v25
    v_and_b32 v114, v147, v26
    v_and_b32 v115, v147, v27
    v_mfma_f32_16x16x32_bf16 v[28:31], v[200:203], v[108:111], v[28:31]
    s_waitcnt lgkmcnt(0)
    v_and_b32 v116, v148, v24
    v_and_b32 v117, v148, v25
    v_and_b32 v118, v148, v26
    v_and_b32 v119, v148, v27
    v_mfma_f32_16x16x32_bf16 v[28:31], v[204:207], v[112:115], v[28:31]
    v_and_b32 v120, v149, v24
    v_and_b32 v121, v149, v25
    v_and_b32 v122, v149, v26
    v_and_b32 v123, v149, v27
    v_mfma_f32_16x16x32_bf16 v[28:31], v[208:211], v[116:119], v[28:31]
    v_and_b32 v124, v150, v24
    v_and_b32 v125, v150, v25
    v_and_b32 v126, v150, v26
    v_and_b32 v127, v150, v27
    v_mfma_f32_16x16x32_bf16 v[28:31], v[212:215], v[120:123], v[28:31]
    v_and_b32 v128, v151, v24
    v_and_b32 v129, v151, v25
    v_and_b32 v130, v151, v26
    v_and_b32 v131, v151, v27
    v_mfma_f32_16x16x32_bf16 v[28:31], v[216:219], v[124:127], v[28:31]
    s_nop 0
    v_mfma_f32_16x16x32_bf16 v[28:31], v[220:223], v[128:131], v[28:31]
    s_nop 7
    ds_write_b128 v10, v[28:31] offset:21504
    v_mov_b32 v40, 0
    v_mov_b32 v41, 1
    s_mov_b64 exec, 1
    ds_add_rtn_u32 v42, v40, v41 offset:12
    s_mov_b64 exec, -1
    s_waitcnt lgkmcnt(0)
    v_readfirstlane_b32 s38, v42
    s_cmp_lg_u32 s38, 2
    s_nop 2
    s_cbranch_scc1 L_claim
    ds_read_b128 v[136:139], v13 offset:21504
    ds_read_b128 v[140:143], v13 offset:22528
    ds_read_b128 v[144:147], v13 offset:23552
    s_waitcnt lgkmcnt(0)
    v_add_f32 v136, v136, v140
    v_add_f32 v137, v137, v141
    v_add_f32 v138, v138, v142
    v_add_f32 v139, v139, v143
    v_add_f32 v136, v136, v144
    v_add_f32 v137, v137, v145
    v_add_f32 v138, v138, v146
    v_add_f32 v139, v139, v147
    v_and_or_b32 v136, v136, v12, s20
    v_and_or_b32 v137, v137, v12, s21
    v_and_or_b32 v138, v138, v12, s22
    v_and_or_b32 v139, v139, v12, s23
    v_mov_b32 v16, 0
    s_mov_b32 s40, 200000
L_fd0:
    ds_read_b32 v17, v16 offset:0
    s_waitcnt lgkmcnt(0)
    v_readfirstlane_b32 s52, v17
    s_cmp_ge_i32 s52, 0
    s_nop 2
    s_cbranch_scc1 L_fd0_done
    s_sleep 64
    s_sub_u32 s40, s40, 1
    s_cmp_lg_u32 s40, 0
    s_cbranch_scc1 L_fd0
L_fd0_done:
    v_mov_b32 v16, 0
    s_mov_b32 s40, 200000
L_fd1:
    ds_read_b32 v17, v16 offset:20
    s_waitcnt lgkmcnt(0)
    v_readfirstlane_b32 s52, v17
    s_cmp_ge_i32 s52, 1
    s_nop 2
    s_cbranch_scc1 L_fd1_done
    s_sleep 2
    s_sub_u32 s40, s40, 1
    s_cmp_lg_u32 s40, 0
    s_cbranch_scc1 L_fd1
L_fd1_done:
    global_store_dwordx4 v11, v[136:139], s[88:89] sc1
L_claim:
    s_cmp_lg_u32 s29, 3
    s_cbranch_scc1 L_cdone1
    v_mov_b32 v13, 8
    v_subrev_u32 v17, 0, v1
    v_med3_i32 v17, v17, 0, 8
    v_mad_u32_u24 v13, v17, 7, v13
    v_subrev_u32 v17, 8, v1
    v_med3_i32 v17, v17, 0, 8
    v_mad_u32_u24 v13, v17, 4, v13
    v_subrev_u32 v17, 16, v1
    v_med3_i32 v17, v17, 0, 8
    v_mad_u32_u24 v13, v17, 2, v13
    v_subrev_u32 v17, 24, v1
    v_med3_i32 v17, v17, 0, 16
    v_mad_u32_u24 v13, v17, 1, v13
    s_mul_i32 s50, s4, 4352
    s_add_u32 s50, s50, 3149824
    v_mov_b32 v14, s50
    v_mov_b32 v15, 1
    v_mov_b32 v16, 0
    s_mov_b32 s50, 1
    s_mov_b32 s51, 0
    v_lshrrev_b32 v20, 4, v1
    v_mul_u32_u24 v20, 192, v20
    v_and_b32 v21, 15, v1
    v_min_u32 v21, 11, v21
    v_lshl_add_u32 v20, v21, 4, v20
    v_mov_b32 v21, 0
    s_lshl_b32 s58, s2, 1
    s_add_u32 s58, s58, 0
    s_lshl_b32 s58, s58, 10
    s_add_u32 s58, s58, 1048576
    v_lshl_add_u32 v22, v1, 4, s58
    s_mov_b32 s40, 200000
L_cmid1:
    s_sleep 16
    ds_read_b32 v17, v16 offset:16
    s_waitcnt lgkmcnt(0)
    v_readfirstlane_b32 s52, v17
    s_sub_u32 s40, s40, 1
    s_cmp_eq_u32 s40, 0
    s_nop 1
    s_cbranch_scc1 L_cdone1
    s_cmp_lt_u32 s52, 4
    s_cbranch_scc1 L_cmid1
    ds_read_b128 v[96:99], v21 offset:896
    ds_read_b128 v[100:103], v21 offset:912
    ds_read_b128 v[64:67], v20 offset:8192
    ds_read_b128 v[68:71], v20 offset:8960
    ds_read_b128 v[72:75], v20 offset:9728
    ds_read_b128 v[76:79], v20 offset:10496
    ds_read_b128 v[80:83], v20 offset:11264
    ds_read_b128 v[84:87], v20 offset:12032
    ds_read_b128 v[88:91], v20 offset:12800
    ds_read_b128 v[92:95], v20 offset:13568
    v_mov_b32 v106, 0xffffff00
    s_waitcnt lgkmcnt(8)
    v_max3_f32 v104, v96, v98, v100
    v_max_f32 v104, v104, v102
    v_sub_f32 v96, v96, v104
    v_sub_f32 v98, v98, v104
    v_sub_f32 v100, v100, v104
    v_sub_f32 v102, v102, v104
    v_exp_f32 v96, v96
    v_exp_f32 v98, v98
    v_exp_f32 v100, v100
    v_exp_f32 v102, v102
    v_mul_f32 v105, v96, v97
    v_fma_f32 v105, v98, v99, v105
    v_fma_f32 v105, v100, v101, v105
    v_fma_f32 v105, v102, v103, v105
    v_lshlrev_b32 v107, 8, v104
    v_lshlrev_b32 v108, 8, v105
    s_waitcnt lgkmcnt(0)
    v_add_f32 v64, v64, v68
    v_add_f32 v65, v65, v69
    v_add_f32 v66, v66, v70
    v_add_f32 v67, v67, v71
    v_add_f32 v72, v72, v76
    v_add_f32 v73, v73, v77
    v_add_f32 v74, v74, v78
    v_add_f32 v75, v75, v79
    v_add_f32 v80, v80, v84
    v_add_f32 v81, v81, v85
    v_add_f32 v82, v82, v86
    v_add_f32 v83, v83, v87
    v_add_f32 v88, v88, v92
    v_add_f32 v89, v89, v93
    v_add_f32 v90, v90, v94
    v_add_f32 v91, v91, v95
    v_mul_f32 v64, v64, v96
    v_mul_f32 v65, v65, v96
    v_mul_f32 v66, v66, v96
    v_mul_f32 v67, v67, v96
    v_fma_f32 v64, v72, v98, v64
    v_fma_f32 v65, v73, v98, v65
    v_fma_f32 v66, v74, v98, v66
    v_fma_f32 v67, v75, v98, v67
    v_fma_f32 v64, v80, v100, v64
    v_fma_f32 v65, v81, v100, v65
    v_fma_f32 v66, v82, v100, v66
    v_fma_f32 v67, v83, v100, v67
    v_fma_f32 v64, v88, v102, v64
    v_fma_f32 v65, v89, v102, v65
    v_fma_f32 v66, v90, v102, v66
    v_fma_f32 v67, v91, v102, v67
    s_mov_b32 exec_lo, 0x10001000
    s_mov_b32 exec_hi, 0x10001000
    v_mov_b32 v64, v104
    v_mov_b32 v65, v105
    v_mov_b32 v66, v107
    v_mov_b32 v67, v108
    s_mov_b64 exec, -1
    v_and_or_b32 v64, v64, v106, s20
    v_and_or_b32 v65, v65, v106, s21
    v_and_or_b32 v66, v66, v106, s22
    v_and_or_b32 v67, v67, v106, s23
    s_mov_b32 s59, 32
    s_mov_b64 exec, -1
    s_mov_b64 exec, 1
    s_mov_b32 s40, 200000
L_ctag1:
    global_load_dwordx2 v[18:19], v14, s[88:89] sc1
    s_waitcnt vmcnt(0)
    v_cmp_ne_u32 vcc, s47, v19
    s_nop 0
    s_cbranch_vccz L_ctag1_done
    s_mov_b64 exec, vcc
    s_sleep 8
    s_sub_u32 s40, s40, 1
    s_cmp_lg_u32 s40, 0
    s_cbranch_scc1 L_ctag1
L_ctag1_done:
    s_mov_b64 exec, -1
    s_mov_b32 s40, 200000
L_cidle1:
    s_sleep 8
    ds_read_b32 v17, v16 offset:0
    s_waitcnt lgkmcnt(0)
    v_readfirstlane_b32 s52, v17
    s_sub_u32 s40, s40, 1
    s_cmp_eq_u32 s40, 0
    s_nop 1
    s_cbranch_scc1 L_cdone1
    s_cmp_lt_i32 s52, 0
    s_cbranch_scc1 L_cidle1
L_cwait1:
    ds_read_b32 v17, v16 offset:0
    s_waitcnt lgkmcnt(0)
    v_readfirstlane_b32 s52, v17
    s_cmp_ge_u32 s52, s51
    s_nop 2
    s_cbranch_scc1 L_cgo1
    s_sleep 1
    s_sub_u32 s40, s40, 1
    s_cmp_lg_u32 s40, 0
    s_cbranch_scc1 L_cwait1
    s_branch L_cdone1
L_cgo1:
    s_mov_b64 exec, 1
    global_atomic_add v17, v14, v15, s[88:89] sc0 sc1
    s_mov_b64 exec, -1
    v_add_u32 v18, s50, v1
    v_lshlrev_b32 v18, 2, v18
    s_cmp_lg_u32 s59, 98
    s_cbranch_scc1 L_cw01
    global_store_dwordx4 v22, v[64:67], s[88:89] sc1
    s_mov_b32 s59, 99
    s_waitcnt vmcnt(1)
    s_branch L_cw11
L_cw01:
    s_waitcnt vmcnt(0)
L_cw11:
    v_readfirstlane_b32 s52, v17
    s_nop 0
    s_min_u32 s52, s52, 62
    s_add_u32 s57, s52, 1
    s_nop 0
    v_readlane_b32 s56, v13, s52
    v_readlane_b32 s57, v13, s57
    s_nop 0
    v_add_u32 v17, s56, v1
    s_sub_u32 s57, s57, s56
    s_max_u32 s58, s57, 1
    s_bfm_b64 exec, s58, 0
    ds_write_b32 v18, v17 offset:25600
    s_mov_b64 exec, -1
    s_cmp_lt_u32 s52, 32
    s_cbranch_scc1 L_cnfl1
    ds_write_b32 v16, v15 offset:20
L_cnfl1:
    s_cmp_lt_u32 s52, s59
    s_cbranch_scc1 L_cnp1
    s_mov_b32 s59, 98
    s_cmp_lg_u32 s57, 0
    s_cbranch_scc1 L_cnp1
    s_mov_b32 s59, 99
    global_store_dwordx4 v22, v[64:67], s[88:89] sc1
L_cnp1:
    s_add_u32 s50, s50, s57
    s_cmp_ge_u32 s57, 3
    s_cselect_b32 s58, 2, 1
    s_sub_u32 s51, s50, s58
    s_cmp_lg_u32 s57, 0
    s_cbranch_scc1 L_cwait1
L_cdone1:
    s_branch L_exit
L_reducer:
    s_lshl_b32 s38, s26, 2
    s_add_u32 s38, s38, s29
    s_lshr_b32 s41, s38, 3
    s_and_b32 s44, s38, 7
    s_mul_i32 s39, s41, 40960
    s_lshl_b32 s45, s44, 7
    s_add_u32 s39, s39, s45
    s_add_u32 s39, s39, 2097152
    v_lshrrev_b32 v44, 3, v1
    v_lshl_add_u32 v44, v44, 10, s39
    v_and_b32 v51, 7, v1
    v_lshl_add_u32 v44, v51, 4, v44
    v_add_u32 v45, 8192, v44
    v_add_u32 v46, 16384, v44
    v_add_u32 v47, 24576, v44
    v_add_u32 v48, 32768, v44
    s_lshl_b32 s39, s41, 7
    s_lshr_b32 s45, s44, 1
    s_lshl_b32 s45, s45, 5
    s_add_u32 s39, s39, s45
    v_lshrrev_b32 v144, 4, v1
    v_lshl_add_u32 v144, v144, 3, v51
    v_add_u32 v144, s39, v144
    v_lshlrev_b32 v144, 1, v144
    s_and_b32 s45, s44, 1
    s_mul_i32 s45, s45, 1280
    v_add_u32 v145, s45, v144
    global_load_ushort v146, v144, s[82:83]
    global_load_ushort v147, v145, s[64:65]
    s_waitcnt vmcnt(0)
    s_cmp_lg_u32 s29, 3
    s_cbranch_scc1 L_cdone2
    v_mov_b32 v13, 8
    v_subrev_u32 v17, 0, v1
    v_med3_i32 v17, v17, 0, 8
    v_mad_u32_u24 v13, v17, 7, v13
    v_subrev_u32 v17, 8, v1
    v_med3_i32 v17, v17, 0, 8
    v_mad_u32_u24 v13, v17, 4, v13
    v_subrev_u32 v17, 16, v1
    v_med3_i32 v17, v17, 0, 8
    v_mad_u32_u24 v13, v17, 2, v13
    v_subrev_u32 v17, 24, v1
    v_med3_i32 v17, v17, 0, 16
    v_mad_u32_u24 v13, v17, 1, v13
    s_mul_i32 s50, s4, 4352
    s_add_u32 s50, s50, 3149824
    v_mov_b32 v14, s50
    v_mov_b32 v15, 1
    v_mov_b32 v16, 0
    s_mov_b32 s50, 1
    s_mov_b32 s51, 0
    v_lshrrev_b32 v20, 4, v1
    v_mul_u32_u24 v20, 192, v20
    v_and_b32 v21, 15, v1
    v_min_u32 v21, 11, v21
    v_lshl_add_u32 v20, v21, 4, v20
    v_mov_b32 v21, 0
    s_lshl_b32 s58, s2, 1
    s_add_u32 s58, s58, 0
    s_lshl_b32 s58, s58, 10
    s_add_u32 s58, s58, 1048576
    v_lshl_add_u32 v22, v1, 4, s58
    s_mov_b32 s40, 200000
L_cmid2:
    s_sleep 16
    ds_read_b32 v17, v16 offset:16
    s_waitcnt lgkmcnt(0)
    v_readfirstlane_b32 s52, v17
    s_sub_u32 s40, s40, 1
    s_cmp_eq_u32 s40, 0
    s_nop 1
    s_cbranch_scc1 L_cdone2
    s_cmp_lt_u32 s52, 4
    s_cbranch_scc1 L_cmid2
    ds_read_b128 v[96:99], v21 offset:896
    ds_read_b128 v[100:103], v21 offset:912
    ds_read_b128 v[64:67], v20 offset:8192
    ds_read_b128 v[68:71], v20 offset:8960
    ds_read_b128 v[72:75], v20 offset:9728
    ds_read_b128 v[76:79], v20 offset:10496
    ds_read_b128 v[80:83], v20 offset:11264
    ds_read_b128 v[84:87], v20 offset:12032
    ds_read_b128 v[88:91], v20 offset:12800
    ds_read_b128 v[92:95], v20 offset:13568
    v_mov_b32 v106, 0xffffff00
    s_waitcnt lgkmcnt(8)
    v_max3_f32 v104, v96, v98, v100
    v_max_f32 v104, v104, v102
    v_sub_f32 v96, v96, v104
    v_sub_f32 v98, v98, v104
    v_sub_f32 v100, v100, v104
    v_sub_f32 v102, v102, v104
    v_exp_f32 v96, v96
    v_exp_f32 v98, v98
    v_exp_f32 v100, v100
    v_exp_f32 v102, v102
    v_mul_f32 v105, v96, v97
    v_fma_f32 v105, v98, v99, v105
    v_fma_f32 v105, v100, v101, v105
    v_fma_f32 v105, v102, v103, v105
    v_lshlrev_b32 v107, 8, v104
    v_lshlrev_b32 v108, 8, v105
    s_waitcnt lgkmcnt(0)
    v_add_f32 v64, v64, v68
    v_add_f32 v65, v65, v69
    v_add_f32 v66, v66, v70
    v_add_f32 v67, v67, v71
    v_add_f32 v72, v72, v76
    v_add_f32 v73, v73, v77
    v_add_f32 v74, v74, v78
    v_add_f32 v75, v75, v79
    v_add_f32 v80, v80, v84
    v_add_f32 v81, v81, v85
    v_add_f32 v82, v82, v86
    v_add_f32 v83, v83, v87
    v_add_f32 v88, v88, v92
    v_add_f32 v89, v89, v93
    v_add_f32 v90, v90, v94
    v_add_f32 v91, v91, v95
    v_mul_f32 v64, v64, v96
    v_mul_f32 v65, v65, v96
    v_mul_f32 v66, v66, v96
    v_mul_f32 v67, v67, v96
    v_fma_f32 v64, v72, v98, v64
    v_fma_f32 v65, v73, v98, v65
    v_fma_f32 v66, v74, v98, v66
    v_fma_f32 v67, v75, v98, v67
    v_fma_f32 v64, v80, v100, v64
    v_fma_f32 v65, v81, v100, v65
    v_fma_f32 v66, v82, v100, v66
    v_fma_f32 v67, v83, v100, v67
    v_fma_f32 v64, v88, v102, v64
    v_fma_f32 v65, v89, v102, v65
    v_fma_f32 v66, v90, v102, v66
    v_fma_f32 v67, v91, v102, v67
    s_mov_b32 exec_lo, 0x10001000
    s_mov_b32 exec_hi, 0x10001000
    v_mov_b32 v64, v104
    v_mov_b32 v65, v105
    v_mov_b32 v66, v107
    v_mov_b32 v67, v108
    s_mov_b64 exec, -1
    v_and_or_b32 v64, v64, v106, s20
    v_and_or_b32 v65, v65, v106, s21
    v_and_or_b32 v66, v66, v106, s22
    v_and_or_b32 v67, v67, v106, s23
    s_mov_b32 s59, 32
    s_mov_b64 exec, -1
    s_mov_b64 exec, 1
    s_mov_b32 s40, 200000
L_ctag2:
    global_load_dwordx2 v[18:19], v14, s[88:89] sc1
    s_waitcnt vmcnt(0)
    v_cmp_ne_u32 vcc, s47, v19
    s_nop 0
    s_cbranch_vccz L_ctag2_done
    s_mov_b64 exec, vcc
    s_sleep 8
    s_sub_u32 s40, s40, 1
    s_cmp_lg_u32 s40, 0
    s_cbranch_scc1 L_ctag2
L_ctag2_done:
    s_mov_b64 exec, -1
    s_mov_b32 s40, 200000
L_cidle2:
    s_sleep 8
    ds_read_b32 v17, v16 offset:0
    s_waitcnt lgkmcnt(0)
    v_readfirstlane_b32 s52, v17
    s_sub_u32 s40, s40, 1
    s_cmp_eq_u32 s40, 0
    s_nop 1
    s_cbranch_scc1 L_cdone2
    s_cmp_lt_i32 s52, 0
    s_cbranch_scc1 L_cidle2
L_cwait2:
    ds_read_b32 v17, v16 offset:0
    s_waitcnt lgkmcnt(0)
    v_readfirstlane_b32 s52, v17
    s_cmp_ge_u32 s52, s51
    s_nop 2
    s_cbranch_scc1 L_cgo2
    s_sleep 1
    s_sub_u32 s40, s40, 1
    s_cmp_lg_u32 s40, 0
    s_cbranch_scc1 L_cwait2
    s_branch L_cdone2
L_cgo2:
    s_mov_b64 exec, 1
    global_atomic_add v17, v14, v15, s[88:89] sc0 sc1
    s_mov_b64 exec, -1
    v_add_u32 v18, s50, v1
    v_lshlrev_b32 v18, 2, v18
    s_cmp_lg_u32 s59, 98
    s_cbranch_scc1 L_cw02
    global_store_dwordx4 v22, v[64:67], s[88:89] sc1
    s_mov_b32 s59, 99
    s_waitcnt vmcnt(1)
    s_branch L_cw12
L_cw02:
    s_waitcnt vmcnt(0)
L_cw12:
    v_readfirstlane_b32 s52, v17
    s_nop 0
    s_min_u32 s52, s52, 62
    s_add_u32 s57, s52, 1
    s_nop 0
    v_readlane_b32 s56, v13, s52
    v_readlane_b32 s57, v13, s57
    s_nop 0
    v_add_u32 v17, s56, v1
    s_sub_u32 s57, s57, s56
    s_max_u32 s58, s57, 1
    s_bfm_b64 exec, s58, 0
    ds_write_b32 v18, v17 offset:25600
    s_mov_b64 exec, -1
    s_cmp_lt_u32 s52, s59
    s_cbranch_scc1 L_cnp2
    s_mov_b32 s59, 98
    s_cmp_lg_u32 s57, 0
    s_cbranch_scc1 L_cnp2
    s_mov_b32 s59, 99
    global_store_dwordx4 v22, v[64:67], s[88:89] sc1
L_cnp2:
    s_add_u32 s50, s50, s57
    s_cmp_ge_u32 s57, 3
    s_cselect_b32 s58, 2, 1
    s_sub_u32 s51, s50, s58
    s_cmp_lg_u32 s57, 0
    s_cbranch_scc1 L_cwait2
L_cdone2:
    s_barrier
    s_mov_b32 s40, 200000
L_pollF:
    global_load_dwordx4 v[128:131], v48, s[88:89] sc1
    s_waitcnt vmcnt(0)
    v_xor_b32 v128, s20, v128
    v_xor_b32 v129, s21, v129
    v_xor_b32 v130, s22, v130
    v_xor_b32 v131, s23, v131
    v_or3_b32 v40, v128, v129, v130
    v_or_b32 v40, v40, v131
    v_and_b32 v40, 0xff, v40
    v_cmp_ne_u32 vcc, 0, v40
    s_nop 0
    s_cbranch_vccz L_pollF_done
    s_mov_b64 exec, vcc
    s_sleep 2
    s_sub_u32 s40, s40, 1
    s_cmp_lg_u32 s40, 0
    s_cbranch_scc1 L_pollF
L_pollF_done:
    s_mov_b64 exec, -1
    v_permlane32_swap_b32 v128, v130
    v_permlane32_swap_b32 v129, v131
    v_add_f32 v128, v128, v130
    v_add_f32 v129, v129, v131
    s_nop 1
    v_permlane16_swap_b32 v128, v129
    v_add_f32 v128, v128, v129
    s_nop 1
    v_add_f32_dpp v128, v128, v128 row_ror:8 row_mask:0xf bank_mask:0xf
    v_cvt_pk_bf16_f32 v128, v128, v128
    v_and_b32 v128, 0xffff0000, v128
    v_lshlrev_b32 v146, 16, v146
    v_lshlrev_b32 v147, 16, v147
    v_add_f32 v128, v128, v146
    v_cvt_pk_bf16_f32 v128, v128, v128
    v_and_b32 v128, 0xffff0000, v128
    v_mul_f32 v129, 0x3fb8aa3b, v128
    v_exp_f32 v129, -v129
    s_nop 0
    v_add_f32 v129, 1.0, v129
    v_rcp_f32 v129, v129
    s_nop 0
    v_mul_f32 v128, v128, v129
    v_cvt_pk_bf16_f32 v128, v128, v128
    v_and_b32 v128, 0xffff0000, v128
    v_mov_b32 v148, 3145728
    v_mov_b32 v149, s47
    s_mov_b32 s40, 200000
L_pollB:
    global_load_dwordx4 v[160:163], v44, s[88:89] sc1
    global_load_dwordx4 v[164:167], v45, s[88:89] sc1
    global_load_dwordx4 v[168:171], v46, s[88:89] sc1
    global_load_dwordx4 v[172:175], v47, s[88:89] sc1
    s_waitcnt vmcnt(0)
    v_xor_b32 v112, s20, v160
    v_xor_b32 v113, s21, v161
    v_xor_b32 v114, s22, v162
    v_xor_b32 v115, s23, v163
    v_xor_b32 v116, s20, v164
    v_xor_b32 v117, s21, v165
    v_xor_b32 v118, s22, v166
    v_xor_b32 v119, s23, v167
    v_xor_b32 v120, s20, v168
    v_xor_b32 v121, s21, v169
    v_xor_b32 v122, s22, v170
    v_xor_b32 v123, s23, v171
    v_xor_b32 v124, s20, v172
    v_xor_b32 v125, s21, v173
    v_xor_b32 v126, s22, v174
    v_xor_b32 v127, s23, v175
    v_or3_b32 v40, v112, v113, v114
    v_or3_b32 v40, v40, v115, v116
    v_or3_b32 v40, v40, v117, v118
    v_or3_b32 v40, v40, v119, v120
    v_or3_b32 v40, v40, v121, v122
    v_or3_b32 v40, v40, v123, v124
    v_or3_b32 v40, v40, v125, v126
    v_or_b32 v40, v40, v127
    v_and_b32 v40, 0xff, v40
    v_cmp_ne_u32 vcc, 0, v40
    s_nop 0
    s_cbranch_vccz L_pollB_done
    s_mov_b64 exec, vcc
    global_load_dwordx4 v[160:163], v44, s[88:89] sc1
    global_load_dwordx4 v[164:167], v45, s[88:89] sc1
    global_load_dwordx4 v[168:171], v46, s[88:89] sc1
    global_load_dwordx4 v[172:175], v47, s[88:89] sc1
    s_sleep 5
    global_load_dwordx4 v[176:179], v44, s[88:89] sc1
    global_load_dwordx4 v[180:183], v45, s[88:89] sc1
    global_load_dwordx4 v[184:187], v46, s[88:89] sc1
    global_load_dwordx4 v[188:191], v47, s[88:89] sc1
    s_sleep 5
L_pollB_loop:
    global_load_dwordx4 v[192:195], v44, s[88:89] sc1
    global_load_dwordx4 v[196:199], v45, s[88:89] sc1
    global_load_dwordx4 v[200:203], v46, s[88:89] sc1
    global_load_dwordx4 v[204:207], v47, s[88:89] sc1
    s_waitcnt vmcnt(8)
    v_xor_b32 v112, s20, v160
    v_xor_b32 v113, s21, v161
    v_xor_b32 v114, s22, v162
    v_xor_b32 v115, s23, v163
    v_xor_b32 v116, s20, v164
    v_xor_b32 v117, s21, v165
    v_xor_b32 v118, s22, v166
    v_xor_b32 v119, s23, v167
    v_xor_b32 v120, s20, v168
    v_xor_b32 v121, s21, v169
    v_xor_b32 v122, s22, v170
    v_xor_b32 v123, s23, v171
    v_xor_b32 v124, s20, v172
    v_xor_b32 v125, s21, v173
    v_xor_b32 v126, s22, v174
    v_xor_b32 v127, s23, v175
    v_or3_b32 v40, v112, v113, v114
    v_or3_b32 v40, v40, v115, v116
    v_or3_b32 v40, v40, v117, v118
    v_or3_b32 v40, v40, v119, v120
    v_or3_b32 v40, v40, v121, v122
    v_or3_b32 v40, v40, v123, v124
    v_or3_b32 v40, v40, v125, v126
    v_or_b32 v40, v40, v127
    v_and_b32 v40, 0xff, v40
    v_cmp_ne_u32 vcc, 0, v40
    s_nop 0
    s_cbranch_vccz L_pollB_done
    s_mov_b64 exec, vcc
    global_load_dwordx4 v[160:163], v44, s[88:89] sc1
    global_load_dwordx4 v[164:167], v45, s[88:89] sc1
    global_load_dwordx4 v[168:171], v46, s[88:89] sc1
    global_load_dwordx4 v[172:175], v47, s[88:89] sc1
    s_waitcnt vmcnt(8)
    v_xor_b32 v112, s20, v176
    v_xor_b32 v113, s21, v177
    v_xor_b32 v114, s22, v178
    v_xor_b32 v115, s23, v179
    v_xor_b32 v116, s20, v180
    v_xor_b32 v117, s21, v181
    v_xor_b32 v118, s22, v182
    v_xor_b32 v119, s23, v183
    v_xor_b32 v120, s20, v184
    v_xor_b32 v121, s21, v185
    v_xor_b32 v122, s22, v186
    v_xor_b32 v123, s23, v187
    v_xor_b32 v124, s20, v188
    v_xor_b32 v125, s21, v189
    v_xor_b32 v126, s22, v190
    v_xor_b32 v127, s23, v191
    v_or3_b32 v40, v112, v113, v114
    v_or3_b32 v40, v40, v115, v116
    v_or3_b32 v40, v40, v117, v118
    v_or3_b32 v40, v40, v119, v120
    v_or3_b32 v40, v40, v121, v122
    v_or3_b32 v40, v40, v123, v124
    v_or3_b32 v40, v40, v125, v126
    v_or_b32 v40, v40, v127
    v_and_b32 v40, 0xff, v40
    v_cmp_ne_u32 vcc, 0, v40
    s_nop 0
    s_cbranch_vccz L_pollB_done
    s_mov_b64 exec, vcc
    global_load_dwordx4 v[176:179], v44, s[88:89] sc1
    global_load_dwordx4 v[180:183], v45, s[88:89] sc1
    global_load_dwordx4 v[184:187], v46, s[88:89] sc1
    global_load_dwordx4 v[188:191], v47, s[88:89] sc1
    s_waitcnt vmcnt(8)
    v_xor_b32 v112, s20, v192
    v_xor_b32 v113, s21, v193
    v_xor_b32 v114, s22, v194
    v_xor_b32 v115, s23, v195
    v_xor_b32 v116, s20, v196
    v_xor_b32 v117, s21, v197
    v_xor_b32 v118, s22, v198
    v_xor_b32 v119, s23, v199
    v_xor_b32 v120, s20, v200
    v_xor_b32 v121, s21, v201
    v_xor_b32 v122, s22, v202
    v_xor_b32 v123, s23, v203
    v_xor_b32 v124, s20, v204
    v_xor_b32 v125, s21, v205
    v_xor_b32 v126, s22, v206
    v_xor_b32 v127, s23, v207
    v_or3_b32 v40, v112, v113, v114
    v_or3_b32 v40, v40, v115, v116
    v_or3_b32 v40, v40, v117, v118
    v_or3_b32 v40, v40, v119, v120
    v_or3_b32 v40, v40, v121, v122
    v_or3_b32 v40, v40, v123, v124
    v_or3_b32 v40, v40, v125, v126
    v_or_b32 v40, v40, v127
    v_and_b32 v40, 0xff, v40
    v_cmp_ne_u32 vcc, 0, v40
    s_nop 0
    s_cbranch_vccz L_pollB_done
    s_mov_b64 exec, vcc
    s_sub_u32 s40, s40, 1
    s_cmp_lg_u32 s40, 0
    s_cbranch_scc1 L_pollB_loop
L_pollB_done:
    s_mov_b64 exec, -1
    v_add_f32 v112, v112, v116
    v_add_f32 v113, v113, v117
    v_add_f32 v114, v114, v118
    v_add_f32 v115, v115, v119
    v_add_f32 v120, v120, v124
    v_add_f32 v121, v121, v125
    v_add_f32 v122, v122, v126
    v_add_f32 v123, v123, v127
    v_add_f32 v112, v112, v120
    v_add_f32 v113, v113, v121
    v_add_f32 v114, v114, v122
    v_add_f32 v115, v115, v123
    s_nop 0
    v_permlane32_swap_b32 v112, v114
    v_permlane32_swap_b32 v113, v115
    v_add_f32 v112, v112, v114
    v_add_f32 v113, v113, v115
    s_nop 1
    v_permlane16_swap_b32 v112, v113
    v_add_f32 v112, v112, v113
    s_nop 1
    v_add_f32_dpp v112, v112, v112 row_ror:8 row_mask:0xf bank_mask:0xf
    v_cvt_pk_bf16_f32 v112, v112, v112
    v_and_b32 v112, 0xffff0000, v112
    v_mul_f32 v112, v112, v128
    v_cvt_pk_bf16_f32 v112, v112, v112
    v_and_b32 v112, 0xffff0000, v112
    v_add_f32 v112, v112, v147
    v_cvt_pk_bf16_f32 v112, v112, v112
    s_mov_b32 exec_lo, 0x00ff00ff
    s_mov_b32 exec_hi, 0x00ff00ff
    global_store_short v145, v112, s[84:85]
    s_cmp_lg_u32 s38, 0
    s_cbranch_scc1 L_noep
    s_mov_b64 exec, 1
    global_store_dword v148, v149, s[88:89]
L_noep:
L_exit:
L_end:
    s_endpgm
.section .rodata,"a"
.p2align 6
.amdhsa_kernel recurrent_scan__gqa_block_cached__dense_activation_squared_relu__decode_kernel
  .amdhsa_next_free_vgpr 256
  .amdhsa_next_free_sgpr 96
  .amdhsa_accum_offset 256
  .amdhsa_group_segment_fixed_size 0
  .amdhsa_kernarg_size 104
  .amdhsa_user_sgpr_count 2
  .amdhsa_user_sgpr_kernarg_segment_ptr 1
  .amdhsa_system_sgpr_workgroup_id_x 1
  .amdhsa_float_denorm_mode_32 3
.end_amdhsa_kernel
```
